```python
import torch

def _softmax(x, axis=-1):
    return torch.softmax(x, dim=axis)
def _gelu(x):
    return torch.nn.functional.gelu(x, approximate="tanh")
def _silu(x):
    return torch.nn.functional.silu(x)
def _sigmoid(x):
    return torch.sigmoid(x)
def _layernorm(x, axis=-1, eps=1e-5):
    m = x.mean(dim=axis, keepdim=True)
    v = x.var(dim=axis, keepdim=True, unbiased=False)
    return (x - m) / torch.sqrt(v + eps)
def _scatter_add(tgt, idx, src, axis=0):
    return tgt.clone().index_add_(axis, idx, src)
def _segment_sum(src, seg, n):
    out = torch.zeros((n,) + src.shape[1:], dtype=src.dtype)
    return out.index_add_(0, seg, src)
def _pad(x, pw):
    flat = tuple(v for pair in reversed(pw) for v in pair)
    return torch.nn.functional.pad(x, flat)

kernel_name = 'sequential_preLN__sliding_block__dense_activation_silu__prompt'

def setup_inputs():

    _w = (lambda a: (lambda t: t.to(torch.bfloat16) if t.is_floating_point() else t)(torch.as_tensor(a)))
    def _A_setup():
        B, S, D = 1, 2048, 640
        return {
            "x": _w((lambda *s: torch.randn(*s, dtype=torch.bfloat16) * 0.05)(B, S, D)),
            "wqkv": _w((lambda *s: torch.randn(*s, dtype=torch.bfloat16) * 0.05)(D, 3 * D)),
            "wo": _w((lambda *s: torch.randn(*s, dtype=torch.bfloat16) * 0.05)(D, D)),
        }
    _A_in = _A_setup()

    def _B_setup():
        B, S, D, F = 1, 2048, 640, 1536
        return {
            "x": _w((lambda *s: torch.randn(*s, dtype=torch.bfloat16) * 0.05)(B, S, D)),
            "w1": _w((lambda *s: torch.randn(*s, dtype=torch.bfloat16) * 3.2)(D, F) * (D ** -0.5)),
            "w2": _w((lambda *s: torch.randn(*s, dtype=torch.bfloat16) * 0.4)(F, D) * (F ** -0.5)),
        }
    _B_in = _B_setup()

    return {
        "A_x": _A_in["x"],
        "A_wqkv": _A_in["wqkv"],
        "A_wo": _A_in["wo"],
        "B_x": _B_in["x"],
        "B_w1": _B_in["w1"],
        "B_w2": _B_in["w2"],
    }

def reference(A_x, A_wqkv, A_wo, B_x, B_w1, B_w2):
    def _A_ref(x, wqkv, wo):
        B, S, D = x.shape
        H = 32; Dh = D // H; W = 256
        qkv = (lambda x, *d: x.permute(*d))((x @ wqkv).reshape(B, S, 3, H, Dh), 2, 0, 3, 1, 4)
        q, k, v = qkv[0], qkv[1], qkv[2]
        scores = torch.einsum("bhqd,bhkd->bhqk", q, k) * (Dh ** -0.5)
        idx = torch.arange(S)
        mask = (idx[:, None] - idx[None, :] >= 0) & (idx[:, None] - idx[None, :] < W)
        scores = torch.where(mask[None, None], scores, -1e9)
        p = _softmax(scores, axis=-1)
        o = torch.einsum("bhqk,bhkd->bhqd", p, v)
        return (lambda x, *d: x.permute(*d))(o, 0, 2, 1, 3).reshape(B, S, D) @ wo

    def _B_ref(x, w1, w2):
        h = torch.einsum("bsd,df->bsf", x, w1)
        h = _silu(h)
        out = torch.einsum("bsf,fd->bsd", h, w2)
        return out

    x = A_x
    h = x + _A_ref(_layernorm(x, axis=-1), A_wqkv, A_wo)
    h2 = h + _B_ref(_layernorm(h, axis=-1), B_w1, B_w2)
    return h2
```

```asm
; @launch grid=(256,1,1) block=(512,1,1) lds=163840
.amdgcn_target "amdgcn-amd-amdhsa--gfx950"
.text
.globl sequential_preLN__sliding_block__dense_activation_silu__prompt_kernel
.p2align 8
.type sequential_preLN__sliding_block__dense_activation_silu__prompt_kernel,@function
sequential_preLN__sliding_block__dense_activation_silu__prompt_kernel:
    s_cmp_ge_u32 s2, 256
    s_cbranch_scc1 L_END
    s_load_dwordx16 s[4:19], s[0:1], 0
    s_load_dwordx2 s[20:21], s[0:1], 64
    v_lshrrev_b32 v1, 6, v0
    v_and_b32 v0, 63, v0
    s_and_b32 s40, s2, 7
    v_readfirstlane_b32 s42, v1
    s_lshr_b32 s41, s2, 3
    s_mov_b32 s62, 1024
    s_cmp_ge_u32 s41, 30
    s_cbranch_scc1 L_COLSUM
    s_cmp_ge_u32 s41, 15
    s_cselect_b32 s45, 1, 0
    s_mul_i32 s52, s45, 15
    s_sub_u32 s46, s41, s52
    s_lshl_b32 s43, s40, 8
    s_lshl_b32 s52, s45, 7
    s_add_u32 s43, s43, s52
    s_lshl_b32 s44, s46, 7
    s_cmp_lt_u32 s42, 4
    s_cbranch_scc1 L_C1
    s_cmp_eq_u32 s42, 6
    s_cbranch_scc1 L_S1
    s_cmp_eq_u32 s42, 7
    s_cbranch_scc1 L_X1
    s_setprio 3
    s_cmp_eq_u32 s42, 5
    s_cbranch_scc1 L_w5_1
    v_lshrrev_b32 v1, 3, v0
    v_mul_u32_u24 v1, 1280, v1
    v_lshrrev_b32 v2, 4, v0
    v_and_b32 v3, 7, v0
    v_xor_b32 v4, v3, v2
    v_xor_b32 v5, 4, v4
    v_lshl_add_u32 v8, v4, 4, v1
    v_lshl_add_u32 v9, v5, 4, v1
    v_add_u32 v9, 10240, v9
    v_add_u32 v10, 20480, v8
    v_add_u32 v11, 20480, v9
    v_add_u32 v12, 20480, v10
    v_add_u32 v13, 20480, v11
    v_add_u32 v14, 20480, v12
    v_add_u32 v15, 20480, v13
    v_add_u32 v16, 20480, v14
    v_add_u32 v17, 20480, v15
    v_add_u32 v18, 20480, v16
    v_add_u32 v19, 20480, v17
    v_add_u32 v20, 20480, v18
    v_add_u32 v21, 20480, v19
    v_add_u32 v22, 20480, v20
    v_add_u32 v23, 20480, v21
    s_mul_i32 s52, s43, 1280
    s_mov_b32 s48, 128
    s_mov_b32 s54, 0
    s_waitcnt lgkmcnt(0)
    s_add_u32 s24, s4, s52
    s_addc_u32 s25, s5, 0
    s_sub_u32 s26, 2621440, s52
    s_mov_b32 s27, 0x20000
    s_branch L_j_2
L_w5_1:
    v_lshrrev_b32 v2, 4, v0
    v_mul_u32_u24 v1, 3840, v2
    v_and_b32 v3, 15, v0
    v_lshlrev_b32 v4, 2, v2
    v_xor_b32 v3, v3, v4
    v_lshl_add_u32 v8, v3, 4, v1
    v_add_u32 v9, 15360, v8
    v_add_u32 v10, 15360, v9
    v_add_u32 v11, 15360, v10
    v_add_u32 v12, 15360, v11
    v_add_u32 v13, 15360, v12
    v_add_u32 v14, 15360, v13
    v_add_u32 v15, 15360, v14
    v_add_u32 v16, 15360, v15
    v_add_u32 v17, 15360, v16
    v_add_u32 v18, 15360, v17
    v_add_u32 v19, 15360, v18
    v_add_u32 v20, 15360, v19
    v_add_u32 v21, 15360, v20
    v_add_u32 v22, 15360, v21
    v_add_u32 v23, 15360, v22
    s_lshl_b32 s52, s44, 1
    s_mov_b32 s48, 245760
    s_mov_b32 s54, 16384
    s_waitcnt lgkmcnt(0)
    s_add_u32 s24, s6, s52
    s_addc_u32 s25, s7, 0
    s_sub_u32 s26, 2457600, s52
    s_mov_b32 s27, 0x20000
L_j_2:
    s_mov_b32 s47, 0
    s_add_u32 m0, s54, 0
    s_nop 0
    buffer_load_dwordx4 v8, s[24:27], s47 offen lds
    s_add_u32 m0, m0, s62
    s_nop 0
    buffer_load_dwordx4 v9, s[24:27], s47 offen lds
    s_add_u32 m0, m0, s62
    s_nop 0
    buffer_load_dwordx4 v10, s[24:27], s47 offen lds
    s_add_u32 m0, m0, s62
    s_nop 0
    buffer_load_dwordx4 v11, s[24:27], s47 offen lds
    s_add_u32 m0, m0, s62
    s_nop 0
    buffer_load_dwordx4 v12, s[24:27], s47 offen lds
    s_add_u32 m0, m0, s62
    s_nop 0
    buffer_load_dwordx4 v13, s[24:27], s47 offen lds
    s_add_u32 m0, m0, s62
    s_nop 0
    buffer_load_dwordx4 v14, s[24:27], s47 offen lds
    s_add_u32 m0, m0, s62
    s_nop 0
    buffer_load_dwordx4 v15, s[24:27], s47 offen lds
    s_add_u32 m0, m0, s62
    s_nop 0
    buffer_load_dwordx4 v16, s[24:27], s47 offen lds
    s_add_u32 m0, m0, s62
    s_nop 0
    buffer_load_dwordx4 v17, s[24:27], s47 offen lds
    s_add_u32 m0, m0, s62
    s_nop 0
    buffer_load_dwordx4 v18, s[24:27], s47 offen lds
    s_add_u32 m0, m0, s62
    s_nop 0
    buffer_load_dwordx4 v19, s[24:27], s47 offen lds
    s_add_u32 m0, m0, s62
    s_nop 0
    buffer_load_dwordx4 v20, s[24:27], s47 offen lds
    s_add_u32 m0, m0, s62
    s_nop 0
    buffer_load_dwordx4 v21, s[24:27], s47 offen lds
    s_add_u32 m0, m0, s62
    s_nop 0
    buffer_load_dwordx4 v22, s[24:27], s47 offen lds
    s_add_u32 m0, m0, s62
    s_nop 0
    buffer_load_dwordx4 v23, s[24:27], s47 offen lds
    s_add_u32 s47, s47, s48
    s_add_u32 m0, s54, 32768
    s_nop 0
    buffer_load_dwordx4 v8, s[24:27], s47 offen lds
    s_add_u32 m0, m0, s62
    s_nop 0
    buffer_load_dwordx4 v9, s[24:27], s47 offen lds
    s_add_u32 m0, m0, s62
    s_nop 0
    buffer_load_dwordx4 v10, s[24:27], s47 offen lds
    s_add_u32 m0, m0, s62
    s_nop 0
    buffer_load_dwordx4 v11, s[24:27], s47 offen lds
    s_add_u32 m0, m0, s62
    s_nop 0
    buffer_load_dwordx4 v12, s[24:27], s47 offen lds
    s_add_u32 m0, m0, s62
    s_nop 0
    buffer_load_dwordx4 v13, s[24:27], s47 offen lds
    s_add_u32 m0, m0, s62
    s_nop 0
    buffer_load_dwordx4 v14, s[24:27], s47 offen lds
    s_add_u32 m0, m0, s62
    s_nop 0
    buffer_load_dwordx4 v15, s[24:27], s47 offen lds
    s_add_u32 m0, m0, s62
    s_nop 0
    buffer_load_dwordx4 v16, s[24:27], s47 offen lds
    s_add_u32 m0, m0, s62
    s_nop 0
    buffer_load_dwordx4 v17, s[24:27], s47 offen lds
    s_add_u32 m0, m0, s62
    s_nop 0
    buffer_load_dwordx4 v18, s[24:27], s47 offen lds
    s_add_u32 m0, m0, s62
    s_nop 0
    buffer_load_dwordx4 v19, s[24:27], s47 offen lds
    s_add_u32 m0, m0, s62
    s_nop 0
    buffer_load_dwordx4 v20, s[24:27], s47 offen lds
    s_add_u32 m0, m0, s62
    s_nop 0
    buffer_load_dwordx4 v21, s[24:27], s47 offen lds
    s_add_u32 m0, m0, s62
    s_nop 0
    buffer_load_dwordx4 v22, s[24:27], s47 offen lds
    s_add_u32 m0, m0, s62
    s_nop 0
    buffer_load_dwordx4 v23, s[24:27], s47 offen lds
    s_add_u32 s47, s47, s48
    s_barrier
    s_mov_b32 s32, s20
    s_mov_b32 s33, s21
    s_mov_b32 s34, 268435456
    s_mov_b32 s35, 0x20000
    s_waitcnt vmcnt(16)
    s_barrier
    s_add_u32 m0, s54, 65536
    s_nop 0
    buffer_load_dwordx4 v8, s[24:27], s47 offen lds
    s_add_u32 m0, m0, s62
    s_nop 0
    buffer_load_dwordx4 v9, s[24:27], s47 offen lds
    s_add_u32 m0, m0, s62
    s_nop 0
    buffer_load_dwordx4 v10, s[24:27], s47 offen lds
    s_add_u32 m0, m0, s62
    s_nop 0
    buffer_load_dwordx4 v11, s[24:27], s47 offen lds
    s_add_u32 m0, m0, s62
    s_nop 0
    buffer_load_dwordx4 v12, s[24:27], s47 offen lds
    s_add_u32 m0, m0, s62
    s_nop 0
    buffer_load_dwordx4 v13, s[24:27], s47 offen lds
    s_add_u32 m0, m0, s62
    s_nop 0
    buffer_load_dwordx4 v14, s[24:27], s47 offen lds
    s_add_u32 m0, m0, s62
    s_nop 0
    buffer_load_dwordx4 v15, s[24:27], s47 offen lds
    s_add_u32 m0, m0, s62
    s_nop 0
    buffer_load_dwordx4 v16, s[24:27], s47 offen lds
    s_add_u32 m0, m0, s62
    s_nop 0
    buffer_load_dwordx4 v17, s[24:27], s47 offen lds
    s_add_u32 m0, m0, s62
    s_nop 0
    buffer_load_dwordx4 v18, s[24:27], s47 offen lds
    s_add_u32 m0, m0, s62
    s_nop 0
    buffer_load_dwordx4 v19, s[24:27], s47 offen lds
    s_add_u32 m0, m0, s62
    s_nop 0
    buffer_load_dwordx4 v20, s[24:27], s47 offen lds
    s_add_u32 m0, m0, s62
    s_nop 0
    buffer_load_dwordx4 v21, s[24:27], s47 offen lds
    s_add_u32 m0, m0, s62
    s_nop 0
    buffer_load_dwordx4 v22, s[24:27], s47 offen lds
    s_add_u32 m0, m0, s62
    s_nop 0
    buffer_load_dwordx4 v23, s[24:27], s47 offen lds
    s_add_u32 s47, s47, s48
    s_add_u32 m0, s54, 98304
    s_nop 0
    buffer_load_dwordx4 v8, s[24:27], s47 offen lds
    s_add_u32 m0, m0, s62
    s_nop 0
    buffer_load_dwordx4 v9, s[24:27], s47 offen lds
    s_add_u32 m0, m0, s62
    s_nop 0
    buffer_load_dwordx4 v10, s[24:27], s47 offen lds
    s_add_u32 m0, m0, s62
    s_nop 0
    buffer_load_dwordx4 v11, s[24:27], s47 offen lds
    s_add_u32 m0, m0, s62
    s_nop 0
    buffer_load_dwordx4 v12, s[24:27], s47 offen lds
    s_add_u32 m0, m0, s62
    s_nop 0
    buffer_load_dwordx4 v13, s[24:27], s47 offen lds
    s_add_u32 m0, m0, s62
    s_nop 0
    buffer_load_dwordx4 v14, s[24:27], s47 offen lds
    s_add_u32 m0, m0, s62
    s_nop 0
    buffer_load_dwordx4 v15, s[24:27], s47 offen lds
    s_add_u32 m0, m0, s62
    s_nop 0
    buffer_load_dwordx4 v16, s[24:27], s47 offen lds
    s_add_u32 m0, m0, s62
    s_nop 0
    buffer_load_dwordx4 v17, s[24:27], s47 offen lds
    s_add_u32 m0, m0, s62
    s_nop 0
    buffer_load_dwordx4 v18, s[24:27], s47 offen lds
    s_add_u32 m0, m0, s62
    s_nop 0
    buffer_load_dwordx4 v19, s[24:27], s47 offen lds
    s_add_u32 m0, m0, s62
    s_nop 0
    buffer_load_dwordx4 v20, s[24:27], s47 offen lds
    s_add_u32 m0, m0, s62
    s_nop 0
    buffer_load_dwordx4 v21, s[24:27], s47 offen lds
    s_add_u32 m0, m0, s62
    s_nop 0
    buffer_load_dwordx4 v22, s[24:27], s47 offen lds
    s_add_u32 m0, m0, s62
    s_nop 0
    buffer_load_dwordx4 v23, s[24:27], s47 offen lds
    s_add_u32 s47, s47, s48
    s_mov_b32 s51, 0
    s_mov_b32 s50, 0
L_L1LOOP:
    s_cmp_eq_u32 s51, 7
    s_cbranch_scc1 L_a_3
    s_cmp_gt_u32 s51, 7
    s_cbranch_scc1 L_b_4
    s_waitcnt vmcnt(32)
    s_branch L_t_5
L_a_3:
    s_waitcnt vmcnt(16)
    s_branch L_t_5
L_b_4:
    s_waitcnt vmcnt(0)
L_t_5:
    s_barrier
    s_cmp_gt_u32 s51, 5
    s_cbranch_scc1 L_s_6
    s_add_u32 m0, s54, s50
    s_nop 0
    buffer_load_dwordx4 v8, s[24:27], s47 offen lds
    s_add_u32 m0, m0, s62
    s_nop 0
    buffer_load_dwordx4 v9, s[24:27], s47 offen lds
    s_add_u32 m0, m0, s62
    s_nop 0
    buffer_load_dwordx4 v10, s[24:27], s47 offen lds
    s_add_u32 m0, m0, s62
    s_nop 0
    buffer_load_dwordx4 v11, s[24:27], s47 offen lds
    s_add_u32 m0, m0, s62
    s_nop 0
    buffer_load_dwordx4 v12, s[24:27], s47 offen lds
    s_add_u32 m0, m0, s62
    s_nop 0
    buffer_load_dwordx4 v13, s[24:27], s47 offen lds
    s_add_u32 m0, m0, s62
    s_nop 0
    buffer_load_dwordx4 v14, s[24:27], s47 offen lds
    s_add_u32 m0, m0, s62
    s_nop 0
    buffer_load_dwordx4 v15, s[24:27], s47 offen lds
    s_add_u32 m0, m0, s62
    s_nop 0
    buffer_load_dwordx4 v16, s[24:27], s47 offen lds
    s_add_u32 m0, m0, s62
    s_nop 0
    buffer_load_dwordx4 v17, s[24:27], s47 offen lds
    s_add_u32 m0, m0, s62
    s_nop 0
    buffer_load_dwordx4 v18, s[24:27], s47 offen lds
    s_add_u32 m0, m0, s62
    s_nop 0
    buffer_load_dwordx4 v19, s[24:27], s47 offen lds
    s_add_u32 m0, m0, s62
    s_nop 0
    buffer_load_dwordx4 v20, s[24:27], s47 offen lds
    s_add_u32 m0, m0, s62
    s_nop 0
    buffer_load_dwordx4 v21, s[24:27], s47 offen lds
    s_add_u32 m0, m0, s62
    s_nop 0
    buffer_load_dwordx4 v22, s[24:27], s47 offen lds
    s_add_u32 m0, m0, s62
    s_nop 0
    buffer_load_dwordx4 v23, s[24:27], s47 offen lds
    s_add_u32 s47, s47, s48
L_s_6:
    s_add_u32 s50, s50, 32768
    s_and_b32 s50, s50, 131071
    s_add_u32 s51, s51, 1
    s_cmp_lt_u32 s51, 10
    s_cbranch_scc1 L_L1LOOP
    s_setprio 0
    s_barrier
    s_branch L_P2
L_S1:
    s_waitcnt lgkmcnt(0)
    s_mov_b32 s32, s20
    s_mov_b32 s33, s21
    s_mov_b32 s34, 268435456
    s_mov_b32 s35, 0x20000
    s_getreg_b32 s55, hwreg(HW_REG_XCC_ID, 0, 4)
    v_mov_b32 v2, 0
    s_lshl_b32 s52, s2, 7
    v_mov_b32 v3, s52
    s_lshl_b32 s52, s40, 8
    s_lshl_b32 s53, s41, 2
    s_add_u32 s52, s52, s53
    s_add_u32 s52, s52, 32768
    v_mov_b32 v4, s52
    v_cmp_eq_u32 vcc, 0, v0
    s_nop 1
    v_cndmask_b32 v3, v4, v3, vcc
    s_mov_b64 exec, 3
    buffer_store_dword v2, v3, s[32:35], 0 offen sc1
    s_mov_b64 exec, -1
    s_mov_b32 s36, s4
    s_mov_b32 s37, s5
    s_mov_b32 s38, 2621440
    s_mov_b32 s39, 0x20000
    s_cmp_ge_u32 s46, 8
    s_cbranch_scc1 L_nostat_7
    s_lshl_b32 s52, s46, 4
    s_add_u32 s52, s52, s43
    s_add_u32 s52, s52, 0
    v_lshrrev_b32 v1, 4, v0
    v_add_u32 v7, s52, v1
    v_mul_u32_u24 v2, 1280, v7
    v_and_b32 v1, 15, v0
    v_lshl_add_u32 v2, v1, 4, v2
    v_add_u32 v5, 5120, v2
    buffer_load_dwordx4 v[32:35], v2, s[36:39], 0 offen offset:0
    buffer_load_dwordx4 v[36:39], v2, s[36:39], 0 offen offset:256
    buffer_load_dwordx4 v[40:43], v2, s[36:39], 0 offen offset:512
    buffer_load_dwordx4 v[44:47], v2, s[36:39], 0 offen offset:768
    buffer_load_dwordx4 v[48:51], v2, s[36:39], 0 offen offset:1024
    buffer_load_dwordx4 v[52:55], v5, s[36:39], 0 offen offset:0
    buffer_load_dwordx4 v[56:59], v5, s[36:39], 0 offen offset:256
    buffer_load_dwordx4 v[60:63], v5, s[36:39], 0 offen offset:512
    buffer_load_dwordx4 v[64:67], v5, s[36:39], 0 offen offset:768
    buffer_load_dwordx4 v[68:71], v5, s[36:39], 0 offen offset:1024
L_nostat_7:
    s_barrier
    s_barrier
    s_waitcnt vmcnt(0)
    s_lshl_b32 s52, s40, 5
    s_add_u32 s52, s52, s41
    s_and_b32 s53, s52, 3
    s_lshl_b32 s53, s53, 3
    s_and_b32 s52, s52, 0xfc
    s_or_b32 s63, s55, 0x80
    s_lshl_b32 s63, s63, s53
    s_atomic_or s63, s[18:19], s52
    s_cmp_ge_u32 s46, 8
    s_cbranch_scc1 L_nostat_8
    v_mov_b32 v72, 0
    v_mov_b32 v73, 0
    v_mov_b32 v74, 0
    v_mov_b32 v75, 0
    v_mov_b32 v4, 0x3f803f80
    v_dot2_f32_bf16 v72, v32, v4, v72
    v_dot2_f32_bf16 v73, v32, v32, v73
    v_dot2_f32_bf16 v74, v52, v4, v74
    v_dot2_f32_bf16 v75, v52, v52, v75
    v_dot2_f32_bf16 v72, v33, v4, v72
    v_dot2_f32_bf16 v73, v33, v33, v73
    v_dot2_f32_bf16 v74, v53, v4, v74
    v_dot2_f32_bf16 v75, v53, v53, v75
    v_dot2_f32_bf16 v72, v34, v4, v72
    v_dot2_f32_bf16 v73, v34, v34, v73
    v_dot2_f32_bf16 v74, v54, v4, v74
    v_dot2_f32_bf16 v75, v54, v54, v75
    v_dot2_f32_bf16 v72, v35, v4, v72
    v_dot2_f32_bf16 v73, v35, v35, v73
    v_dot2_f32_bf16 v74, v55, v4, v74
    v_dot2_f32_bf16 v75, v55, v55, v75
    v_dot2_f32_bf16 v72, v36, v4, v72
    v_dot2_f32_bf16 v73, v36, v36, v73
    v_dot2_f32_bf16 v74, v56, v4, v74
    v_dot2_f32_bf16 v75, v56, v56, v75
    v_dot2_f32_bf16 v72, v37, v4, v72
    v_dot2_f32_bf16 v73, v37, v37, v73
    v_dot2_f32_bf16 v74, v57, v4, v74
    v_dot2_f32_bf16 v75, v57, v57, v75
    v_dot2_f32_bf16 v72, v38, v4, v72
    v_dot2_f32_bf16 v73, v38, v38, v73
    v_dot2_f32_bf16 v74, v58, v4, v74
    v_dot2_f32_bf16 v75, v58, v58, v75
    v_dot2_f32_bf16 v72, v39, v4, v72
    v_dot2_f32_bf16 v73, v39, v39, v73
    v_dot2_f32_bf16 v74, v59, v4, v74
    v_dot2_f32_bf16 v75, v59, v59, v75
    v_dot2_f32_bf16 v72, v40, v4, v72
    v_dot2_f32_bf16 v73, v40, v40, v73
    v_dot2_f32_bf16 v74, v60, v4, v74
    v_dot2_f32_bf16 v75, v60, v60, v75
    v_dot2_f32_bf16 v72, v41, v4, v72
    v_dot2_f32_bf16 v73, v41, v41, v73
    v_dot2_f32_bf16 v74, v61, v4, v74
    v_dot2_f32_bf16 v75, v61, v61, v75
    v_dot2_f32_bf16 v72, v42, v4, v72
    v_dot2_f32_bf16 v73, v42, v42, v73
    v_dot2_f32_bf16 v74, v62, v4, v74
    v_dot2_f32_bf16 v75, v62, v62, v75
    v_dot2_f32_bf16 v72, v43, v4, v72
    v_dot2_f32_bf16 v73, v43, v43, v73
    v_dot2_f32_bf16 v74, v63, v4, v74
    v_dot2_f32_bf16 v75, v63, v63, v75
    v_dot2_f32_bf16 v72, v44, v4, v72
    v_dot2_f32_bf16 v73, v44, v44, v73
    v_dot2_f32_bf16 v74, v64, v4, v74
    v_dot2_f32_bf16 v75, v64, v64, v75
    v_dot2_f32_bf16 v72, v45, v4, v72
    v_dot2_f32_bf16 v73, v45, v45, v73
    v_dot2_f32_bf16 v74, v65, v4, v74
    v_dot2_f32_bf16 v75, v65, v65, v75
    v_dot2_f32_bf16 v72, v46, v4, v72
    v_dot2_f32_bf16 v73, v46, v46, v73
    v_dot2_f32_bf16 v74, v66, v4, v74
    v_dot2_f32_bf16 v75, v66, v66, v75
    v_dot2_f32_bf16 v72, v47, v4, v72
    v_dot2_f32_bf16 v73, v47, v47, v73
    v_dot2_f32_bf16 v74, v67, v4, v74
    v_dot2_f32_bf16 v75, v67, v67, v75
    v_dot2_f32_bf16 v72, v48, v4, v72
    v_dot2_f32_bf16 v73, v48, v48, v73
    v_dot2_f32_bf16 v74, v68, v4, v74
    v_dot2_f32_bf16 v75, v68, v68, v75
    v_dot2_f32_bf16 v72, v49, v4, v72
    v_dot2_f32_bf16 v73, v49, v49, v73
    v_dot2_f32_bf16 v74, v69, v4, v74
    v_dot2_f32_bf16 v75, v69, v69, v75
    v_dot2_f32_bf16 v72, v50, v4, v72
    v_dot2_f32_bf16 v73, v50, v50, v73
    v_dot2_f32_bf16 v74, v70, v4, v74
    v_dot2_f32_bf16 v75, v70, v70, v75
    v_dot2_f32_bf16 v72, v51, v4, v72
    v_dot2_f32_bf16 v73, v51, v51, v73
    v_dot2_f32_bf16 v74, v71, v4, v74
    v_dot2_f32_bf16 v75, v71, v71, v75
    v_add_f32_dpp v72, v72, v72 row_ror:8 row_mask:0xf bank_mask:0xf
    v_add_f32_dpp v73, v73, v73 row_ror:8 row_mask:0xf bank_mask:0xf
    v_add_f32_dpp v74, v74, v74 row_ror:8 row_mask:0xf bank_mask:0xf
    v_add_f32_dpp v75, v75, v75 row_ror:8 row_mask:0xf bank_mask:0xf
    v_add_f32_dpp v72, v72, v72 row_ror:4 row_mask:0xf bank_mask:0xf
    v_add_f32_dpp v73, v73, v73 row_ror:4 row_mask:0xf bank_mask:0xf
    v_add_f32_dpp v74, v74, v74 row_ror:4 row_mask:0xf bank_mask:0xf
    v_add_f32_dpp v75, v75, v75 row_ror:4 row_mask:0xf bank_mask:0xf
    v_add_f32_dpp v72, v72, v72 row_ror:2 row_mask:0xf bank_mask:0xf
    v_add_f32_dpp v73, v73, v73 row_ror:2 row_mask:0xf bank_mask:0xf
    v_add_f32_dpp v74, v74, v74 row_ror:2 row_mask:0xf bank_mask:0xf
    v_add_f32_dpp v75, v75, v75 row_ror:2 row_mask:0xf bank_mask:0xf
    v_add_f32_dpp v72, v72, v72 row_ror:1 row_mask:0xf bank_mask:0xf
    v_add_f32_dpp v73, v73, v73 row_ror:1 row_mask:0xf bank_mask:0xf
    v_add_f32_dpp v74, v74, v74 row_ror:1 row_mask:0xf bank_mask:0xf
    v_add_f32_dpp v75, v75, v75 row_ror:1 row_mask:0xf bank_mask:0xf
    v_lshlrev_b32 v7, 3, v7
    v_add_u32 v7, 65536, v7
    v_and_b32 v6, 15, v0
    v_cmp_eq_u32 vcc, 0, v6
    v_mul_f32 v72, 0x3acccccd, v72
    v_mul_f32 v73, 0x3acccccd, v73
    v_fma_f32 v73, -v72, v72, v73
    v_max_f32 v73, 0, v73
    v_add_f32 v73, 0x3727c5ac, v73
    v_rsq_f32 v76, v73
    v_mul_f32 v77, -1.0, v72
    v_mul_f32 v77, v77, v76
    v_mul_f32 v74, 0x3acccccd, v74
    v_mul_f32 v75, 0x3acccccd, v75
    v_fma_f32 v75, -v74, v74, v75
    v_max_f32 v75, 0, v75
    v_add_f32 v75, 0x3727c5ac, v75
    v_rsq_f32 v78, v75
    v_mul_f32 v79, -1.0, v74
    v_mul_f32 v79, v79, v78
    s_and_saveexec_b64 s[58:59], vcc
    buffer_store_dwordx2 v[76:77], v7, s[32:35], 0 offen sc1
    buffer_store_dwordx2 v[78:79], v7, s[32:35], 0 offen offset:32 sc1
    s_mov_b64 exec, s[58:59]
L_nostat_8:
    s_mov_b32 s51, 0
L_S1LOOP:
    s_cmp_eq_u32 s51, 1
    s_cbranch_scc1 L_9
    s_cmp_eq_u32 s51, 5
    s_cbranch_scc1 L_10
    s_cmp_eq_u32 s51, 7
    s_cbranch_scc1 L_11
    s_cmp_eq_u32 s51, 8
    s_cbranch_scc1 L_17
    s_cmp_eq_u32 s51, 9
    s_cbranch_scc1 L_18
    s_branch L_12
L_17:
    s_branch L_ha_20
L_ha_19:
    s_sleep 8
    s_load_dwordx16 s[64:79], s[18:19], 0 glc
    s_load_dwordx16 s[80:95], s[18:19], 64 glc
L_ha_20:
    s_waitcnt lgkmcnt(0)
    s_mov_b32 s52, 0x80808080
    s_and_b32 s52, s52, s64
    s_and_b32 s52, s52, s65
    s_and_b32 s52, s52, s66
    s_and_b32 s52, s52, s67
    s_and_b32 s52, s52, s68
    s_and_b32 s52, s52, s69
    s_and_b32 s52, s52, s70
    s_and_b32 s52, s52, s71
    s_and_b32 s52, s52, s72
    s_and_b32 s52, s52, s73
    s_and_b32 s52, s52, s74
    s_and_b32 s52, s52, s75
    s_and_b32 s52, s52, s76
    s_and_b32 s52, s52, s77
    s_and_b32 s52, s52, s78
    s_and_b32 s52, s52, s79
    s_and_b32 s52, s52, s80
    s_and_b32 s52, s52, s81
    s_and_b32 s52, s52, s82
    s_and_b32 s52, s52, s83
    s_and_b32 s52, s52, s84
    s_and_b32 s52, s52, s85
    s_and_b32 s52, s52, s86
    s_and_b32 s52, s52, s87
    s_and_b32 s52, s52, s88
    s_and_b32 s52, s52, s89
    s_and_b32 s52, s52, s90
    s_and_b32 s52, s52, s91
    s_and_b32 s52, s52, s92
    s_and_b32 s52, s52, s93
    s_and_b32 s52, s52, s94
    s_and_b32 s52, s52, s95
    s_cmp_eq_u32 s52, 0x80808080
    s_cbranch_scc0 L_ha_19
    s_load_dwordx16 s[64:79], s[18:19], 128
    s_load_dwordx16 s[80:95], s[18:19], 192
    s_branch L_12
L_18:
    s_branch L_ha_22
L_ha_21:
    s_sleep 8
    s_load_dwordx16 s[64:79], s[18:19], 128 glc
    s_load_dwordx16 s[80:95], s[18:19], 192 glc
L_ha_22:
    s_waitcnt lgkmcnt(0)
    s_mov_b32 s52, 0x80808080
    s_and_b32 s52, s52, s64
    s_and_b32 s52, s52, s65
    s_and_b32 s52, s52, s66
    s_and_b32 s52, s52, s67
    s_and_b32 s52, s52, s68
    s_and_b32 s52, s52, s69
    s_and_b32 s52, s52, s70
    s_and_b32 s52, s52, s71
    s_and_b32 s52, s52, s72
    s_and_b32 s52, s52, s73
    s_and_b32 s52, s52, s74
    s_and_b32 s52, s52, s75
    s_and_b32 s52, s52, s76
    s_and_b32 s52, s52, s77
    s_and_b32 s52, s52, s78
    s_and_b32 s52, s52, s79
    s_and_b32 s52, s52, s80
    s_and_b32 s52, s52, s81
    s_and_b32 s52, s52, s82
    s_and_b32 s52, s52, s83
    s_and_b32 s52, s52, s84
    s_and_b32 s52, s52, s85
    s_and_b32 s52, s52, s86
    s_and_b32 s52, s52, s87
    s_and_b32 s52, s52, s88
    s_and_b32 s52, s52, s89
    s_and_b32 s52, s52, s90
    s_and_b32 s52, s52, s91
    s_and_b32 s52, s52, s92
    s_and_b32 s52, s52, s93
    s_and_b32 s52, s52, s94
    s_and_b32 s52, s52, s95
    s_cmp_eq_u32 s52, 0x80808080
    s_cbranch_scc0 L_ha_21
    s_branch L_12
L_9:
    s_waitcnt vmcnt(0)
    s_branch L_12
L_10:
    s_branch L_hs_24
L_hs_23:
    s_sleep 8
    s_lshl_b32 s52, s40, 5
    s_load_dwordx8 s[64:71], s[18:19], s52 glc
    s_add_u32 s52, s40, 7
    s_and_b32 s52, s52, 7
    s_lshl_b32 s52, s52, 5
    s_load_dwordx8 s[72:79], s[18:19], s52 glc
    s_lshr_b32 s52, s46, 1
    s_lshl_b32 s52, s52, 5
    s_add_u32 s52, s52, 28
    s_load_dword s80, s[18:19], s52 glc
L_hs_24:
    s_or_b32 s54, s55, 0x80
    s_mul_i32 s54, s54, 0x01010101
    s_waitcnt lgkmcnt(0)
    s_or_b32 s52, s80, 0x00008080
    s_and_b32 s52, s52, s64
    s_and_b32 s52, s52, s65
    s_and_b32 s52, s52, s66
    s_and_b32 s52, s52, s67
    s_and_b32 s52, s52, s68
    s_and_b32 s52, s52, s69
    s_and_b32 s52, s52, s70
    s_and_b32 s52, s52, s71
    s_and_b32 s52, s52, s72
    s_and_b32 s52, s52, s73
    s_and_b32 s52, s52, s74
    s_and_b32 s52, s52, s75
    s_and_b32 s52, s52, s76
    s_and_b32 s52, s52, s77
    s_and_b32 s52, s52, s78
    s_and_b32 s52, s52, s79
    s_and_b32 s52, s52, 0x80808080
    s_cmp_eq_u32 s52, 0x80808080
    s_cbranch_scc0 L_hs_23
    s_mov_b32 s53, 0
    s_xor_b32 s63, s64, s54
    s_and_b32 s63, s63, 0xbfbfbfbf
    s_or_b32 s53, s53, s63
    s_xor_b32 s63, s65, s54
    s_and_b32 s63, s63, 0xbfbfbfbf
    s_or_b32 s53, s53, s63
    s_xor_b32 s63, s66, s54
    s_and_b32 s63, s63, 0xbfbfbfbf
    s_or_b32 s53, s53, s63
    s_xor_b32 s63, s67, s54
    s_and_b32 s63, s63, 0xbfbfbfbf
    s_or_b32 s53, s53, s63
    s_xor_b32 s63, s68, s54
    s_and_b32 s63, s63, 0xbfbfbfbf
    s_or_b32 s53, s53, s63
    s_xor_b32 s63, s69, s54
    s_and_b32 s63, s63, 0xbfbfbfbf
    s_or_b32 s53, s53, s63
    s_xor_b32 s63, s70, s54
    s_and_b32 s63, s63, 0xbfbfbfbf
    s_or_b32 s53, s53, s63
    s_xor_b32 s63, s71, s54
    s_and_b32 s63, s63, 0xbfbfbfbf
    s_or_b32 s53, s53, s63
    s_cmp_eq_u32 s53, 0
    s_cselect_b32 s56, 1, 0
    s_mul_i32 s52, s45, 15
    s_lshl_b32 s52, s52, 3
    s_or_b32 s52, s52, s40
    s_lshl_b32 s52, s52, 7
    s_add_u32 s60, s20, s52
    s_addc_u32 s61, s21, 0
    s_load_dword s64, s[60:61], 0
    s_load_dword s65, s[60:61], 1024
    s_load_dword s66, s[60:61], 2048
    s_load_dword s67, s[60:61], 3072
    s_load_dword s68, s[60:61], 4096
    s_load_dword s69, s[60:61], 5120
    s_load_dword s70, s[60:61], 6144
    s_load_dword s71, s[60:61], 7168
    s_and_b32 s52, s46, 1
    s_add_u32 s52, s52, 30
    s_lshl_b32 s52, s52, 3
    s_lshr_b32 s53, s46, 1
    s_or_b32 s52, s52, s53
    s_lshl_b32 s52, s52, 7
    s_load_dword s72, s[20:21], s52
    s_branch L_12
L_11:
    s_branch L_fl_26
L_fl_25:
    s_sleep 8
    s_mul_i32 s52, s45, 15
    s_lshl_b32 s52, s52, 3
    s_or_b32 s52, s52, s40
    s_lshl_b32 s52, s52, 7
    s_add_u32 s60, s20, s52
    s_addc_u32 s61, s21, 0
    s_load_dword s64, s[60:61], 0 glc
    s_load_dword s65, s[60:61], 1024 glc
    s_load_dword s66, s[60:61], 2048 glc
    s_load_dword s67, s[60:61], 3072 glc
    s_load_dword s68, s[60:61], 4096 glc
    s_load_dword s69, s[60:61], 5120 glc
    s_load_dword s70, s[60:61], 6144 glc
    s_load_dword s71, s[60:61], 7168 glc
    s_and_b32 s52, s46, 1
    s_add_u32 s52, s52, 30
    s_lshl_b32 s52, s52, 3
    s_lshr_b32 s53, s46, 1
    s_or_b32 s52, s52, s53
    s_lshl_b32 s52, s52, 7
    s_load_dword s72, s[20:21], s52 glc
L_fl_26:
    s_waitcnt lgkmcnt(0)
    s_mov_b32 s52, -1
    s_min_u32 s52, s52, s64
    s_min_u32 s52, s52, s65
    s_min_u32 s52, s52, s66
    s_min_u32 s52, s52, s67
    s_min_u32 s52, s52, s68
    s_min_u32 s52, s52, s69
    s_min_u32 s52, s52, s70
    s_min_u32 s52, s52, s71
    s_min_u32 s52, s52, s72
    s_cmp_ge_u32 s52, 1
    s_cbranch_scc0 L_fl_25
    s_load_dwordx16 s[64:79], s[18:19], 0
    s_load_dwordx16 s[80:95], s[18:19], 64
L_12:
    s_barrier
    s_cmp_eq_u32 s51, 1
    s_cbranch_scc1 L_14
    s_cmp_eq_u32 s51, 3
    s_cbranch_scc1 L_15
    s_branch L_13
L_14:
    s_cmp_ge_u32 s46, 8
    s_cbranch_scc1 L_13
    s_lshl_b32 s52, s2, 7
    v_mov_b32 v3, s52
    v_mov_b32 v2, 1
    s_mov_b64 exec, 1
    buffer_store_dword v2, v3, s[32:35], 0 offen sc1
    s_mov_b64 exec, -1
    s_branch L_13
L_15:
    s_lshl_b32 s52, s40, 5
    s_load_dwordx8 s[64:71], s[18:19], s52
    s_add_u32 s52, s40, 7
    s_and_b32 s52, s52, 7
    s_lshl_b32 s52, s52, 5
    s_load_dwordx8 s[72:79], s[18:19], s52
    s_lshr_b32 s52, s46, 1
    s_lshl_b32 s52, s52, 5
    s_add_u32 s52, s52, 28
    s_load_dword s80, s[18:19], s52
L_13:
    s_add_u32 s51, s51, 1
    s_cmp_lt_u32 s51, 10
    s_cbranch_scc1 L_S1LOOP
    s_barrier
    s_lshl_b32 s52, s2, 7
    v_mov_b32 v3, s52
    v_mov_b32 v2, 2
    s_mov_b64 exec, 1
    buffer_store_dword v2, v3, s[32:35], 0 offen sc1
    s_mov_b64 exec, -1
    s_branch L_P2
L_X1:
    s_waitcnt lgkmcnt(0)
    s_cmp_ge_u32 s41, 5
    s_cbranch_scc1 L_cp_27
    s_getpc_b64 s[60:61]
L_pc_28:
    s_sub_u32 s60, s60, L_pc_28-sequential_preLN__sliding_block__dense_activation_silu__prompt_kernel
    s_subb_u32 s61, s61, 0
    s_lshl_b32 s52, s41, 13
    v_lshlrev_b32 v2, 7, v0
    v_add_u32 v2, s52, v2
    v_min_u32 v2, L_CODE_END-sequential_preLN__sliding_block__dense_activation_silu__prompt_kernel-4, v2
    global_load_dword v101, v2, s[60:61]
L_cp_27:
    s_cmp_ge_u32 s41, 2
    s_cbranch_scc1 L_tlb_29
    s_mov_b32 s52, 2097152
    s_load_dword s100, s[20:21], s52
    s_mov_b32 s52, 4194304
    s_load_dword s100, s[20:21], s52
    s_mov_b32 s52, 6291456
    s_load_dword s100, s[20:21], s52
    s_mov_b32 s52, 8388608
    s_load_dword s100, s[20:21], s52
    s_mov_b32 s52, 10485760
    s_load_dword s100, s[20:21], s52
    s_mov_b32 s52, 12582912
    s_load_dword s100, s[20:21], s52
    s_mov_b32 s52, 14680064
    s_load_dword s100, s[20:21], s52
    s_mov_b32 s52, 16777216
    s_load_dword s100, s[20:21], s52
    s_mov_b32 s52, 18874368
    s_load_dword s100, s[20:21], s52
    s_mov_b32 s52, 20971520
    s_load_dword s100, s[20:21], s52
    s_mov_b32 s52, 0
    s_load_dword s100, s[16:17], s52
    s_mov_b32 s52, 2097152
    s_load_dword s100, s[16:17], s52
    s_mov_b32 s52, 0
    s_load_dword s100, s[8:9], s52
    s_mov_b32 s52, 0
    s_load_dword s100, s[12:13], s52
    s_mov_b32 s52, 1900544
    s_load_dword s100, s[12:13], s52
    s_mov_b32 s52, 0
    s_load_dword s100, s[14:15], s52
    s_mov_b32 s52, 1900544
    s_load_dword s100, s[14:15], s52
    s_mov_b32 s52, 2097152
    s_load_dword s100, s[6:7], s52
    s_mov_b32 s52, 2097152
    s_load_dword s100, s[4:5], s52
L_tlb_29:
    s_mov_b32 s32, s20
    s_mov_b32 s33, s21
    s_mov_b32 s34, 268435456
    s_mov_b32 s35, 0x20000
    s_mov_b32 s36, s4
    s_mov_b32 s37, s5
    s_mov_b32 s38, 2621440
    s_mov_b32 s39, 0x20000
    s_cmp_ge_u32 s46, 8
    s_cbranch_scc1 L_nostat_30
    s_lshl_b32 s52, s46, 4
    s_add_u32 s52, s52, s43
    s_add_u32 s52, s52, 8
    v_lshrrev_b32 v1, 4, v0
    v_add_u32 v7, s52, v1
    v_mul_u32_u24 v2, 1280, v7
    v_and_b32 v1, 15, v0
    v_lshl_add_u32 v2, v1, 4, v2
    v_add_u32 v5, 5120, v2
    buffer_load_dwordx4 v[32:35], v2, s[36:39], 0 offen offset:0
    buffer_load_dwordx4 v[36:39], v2, s[36:39], 0 offen offset:256
    buffer_load_dwordx4 v[40:43], v2, s[36:39], 0 offen offset:512
    buffer_load_dwordx4 v[44:47], v2, s[36:39], 0 offen offset:768
    buffer_load_dwordx4 v[48:51], v2, s[36:39], 0 offen offset:1024
    buffer_load_dwordx4 v[52:55], v5, s[36:39], 0 offen offset:0
    buffer_load_dwordx4 v[56:59], v5, s[36:39], 0 offen offset:256
    buffer_load_dwordx4 v[60:63], v5, s[36:39], 0 offen offset:512
    buffer_load_dwordx4 v[64:67], v5, s[36:39], 0 offen offset:768
    buffer_load_dwordx4 v[68:71], v5, s[36:39], 0 offen offset:1024
L_nostat_30:
    s_barrier
    s_barrier
    s_waitcnt vmcnt(0)
    s_cmp_ge_u32 s46, 8
    s_cbranch_scc1 L_nostat_31
    v_mov_b32 v72, 0
    v_mov_b32 v73, 0
    v_mov_b32 v74, 0
    v_mov_b32 v75, 0
    v_mov_b32 v4, 0x3f803f80
    v_dot2_f32_bf16 v72, v32, v4, v72
    v_dot2_f32_bf16 v73, v32, v32, v73
    v_dot2_f32_bf16 v74, v52, v4, v74
    v_dot2_f32_bf16 v75, v52, v52, v75
    v_dot2_f32_bf16 v72, v33, v4, v72
    v_dot2_f32_bf16 v73, v33, v33, v73
    v_dot2_f32_bf16 v74, v53, v4, v74
    v_dot2_f32_bf16 v75, v53, v53, v75
    v_dot2_f32_bf16 v72, v34, v4, v72
    v_dot2_f32_bf16 v73, v34, v34, v73
    v_dot2_f32_bf16 v74, v54, v4, v74
    v_dot2_f32_bf16 v75, v54, v54, v75
    v_dot2_f32_bf16 v72, v35, v4, v72
    v_dot2_f32_bf16 v73, v35, v35, v73
    v_dot2_f32_bf16 v74, v55, v4, v74
    v_dot2_f32_bf16 v75, v55, v55, v75
    v_dot2_f32_bf16 v72, v36, v4, v72
    v_dot2_f32_bf16 v73, v36, v36, v73
    v_dot2_f32_bf16 v74, v56, v4, v74
    v_dot2_f32_bf16 v75, v56, v56, v75
    v_dot2_f32_bf16 v72, v37, v4, v72
    v_dot2_f32_bf16 v73, v37, v37, v73
    v_dot2_f32_bf16 v74, v57, v4, v74
    v_dot2_f32_bf16 v75, v57, v57, v75
    v_dot2_f32_bf16 v72, v38, v4, v72
    v_dot2_f32_bf16 v73, v38, v38, v73
    v_dot2_f32_bf16 v74, v58, v4, v74
    v_dot2_f32_bf16 v75, v58, v58, v75
    v_dot2_f32_bf16 v72, v39, v4, v72
    v_dot2_f32_bf16 v73, v39, v39, v73
    v_dot2_f32_bf16 v74, v59, v4, v74
    v_dot2_f32_bf16 v75, v59, v59, v75
    v_dot2_f32_bf16 v72, v40, v4, v72
    v_dot2_f32_bf16 v73, v40, v40, v73
    v_dot2_f32_bf16 v74, v60, v4, v74
    v_dot2_f32_bf16 v75, v60, v60, v75
    v_dot2_f32_bf16 v72, v41, v4, v72
    v_dot2_f32_bf16 v73, v41, v41, v73
    v_dot2_f32_bf16 v74, v61, v4, v74
    v_dot2_f32_bf16 v75, v61, v61, v75
    v_dot2_f32_bf16 v72, v42, v4, v72
    v_dot2_f32_bf16 v73, v42, v42, v73
    v_dot2_f32_bf16 v74, v62, v4, v74
    v_dot2_f32_bf16 v75, v62, v62, v75
    v_dot2_f32_bf16 v72, v43, v4, v72
    v_dot2_f32_bf16 v73, v43, v43, v73
    v_dot2_f32_bf16 v74, v63, v4, v74
    v_dot2_f32_bf16 v75, v63, v63, v75
    v_dot2_f32_bf16 v72, v44, v4, v72
    v_dot2_f32_bf16 v73, v44, v44, v73
    v_dot2_f32_bf16 v74, v64, v4, v74
    v_dot2_f32_bf16 v75, v64, v64, v75
    v_dot2_f32_bf16 v72, v45, v4, v72
    v_dot2_f32_bf16 v73, v45, v45, v73
    v_dot2_f32_bf16 v74, v65, v4, v74
    v_dot2_f32_bf16 v75, v65, v65, v75
    v_dot2_f32_bf16 v72, v46, v4, v72
    v_dot2_f32_bf16 v73, v46, v46, v73
    v_dot2_f32_bf16 v74, v66, v4, v74
    v_dot2_f32_bf16 v75, v66, v66, v75
    v_dot2_f32_bf16 v72, v47, v4, v72
    v_dot2_f32_bf16 v73, v47, v47, v73
    v_dot2_f32_bf16 v74, v67, v4, v74
    v_dot2_f32_bf16 v75, v67, v67, v75
    v_dot2_f32_bf16 v72, v48, v4, v72
    v_dot2_f32_bf16 v73, v48, v48, v73
    v_dot2_f32_bf16 v74, v68, v4, v74
    v_dot2_f32_bf16 v75, v68, v68, v75
    v_dot2_f32_bf16 v72, v49, v4, v72
    v_dot2_f32_bf16 v73, v49, v49, v73
    v_dot2_f32_bf16 v74, v69, v4, v74
    v_dot2_f32_bf16 v75, v69, v69, v75
    v_dot2_f32_bf16 v72, v50, v4, v72
    v_dot2_f32_bf16 v73, v50, v50, v73
    v_dot2_f32_bf16 v74, v70, v4, v74
    v_dot2_f32_bf16 v75, v70, v70, v75
    v_dot2_f32_bf16 v72, v51, v4, v72
    v_dot2_f32_bf16 v73, v51, v51, v73
    v_dot2_f32_bf16 v74, v71, v4, v74
    v_dot2_f32_bf16 v75, v71, v71, v75
    v_add_f32_dpp v72, v72, v72 row_ror:8 row_mask:0xf bank_mask:0xf
    v_add_f32_dpp v73, v73, v73 row_ror:8 row_mask:0xf bank_mask:0xf
    v_add_f32_dpp v74, v74, v74 row_ror:8 row_mask:0xf bank_mask:0xf
    v_add_f32_dpp v75, v75, v75 row_ror:8 row_mask:0xf bank_mask:0xf
    v_add_f32_dpp v72, v72, v72 row_ror:4 row_mask:0xf bank_mask:0xf
    v_add_f32_dpp v73, v73, v73 row_ror:4 row_mask:0xf bank_mask:0xf
    v_add_f32_dpp v74, v74, v74 row_ror:4 row_mask:0xf bank_mask:0xf
    v_add_f32_dpp v75, v75, v75 row_ror:4 row_mask:0xf bank_mask:0xf
    v_add_f32_dpp v72, v72, v72 row_ror:2 row_mask:0xf bank_mask:0xf
    v_add_f32_dpp v73, v73, v73 row_ror:2 row_mask:0xf bank_mask:0xf
    v_add_f32_dpp v74, v74, v74 row_ror:2 row_mask:0xf bank_mask:0xf
    v_add_f32_dpp v75, v75, v75 row_ror:2 row_mask:0xf bank_mask:0xf
    v_add_f32_dpp v72, v72, v72 row_ror:1 row_mask:0xf bank_mask:0xf
    v_add_f32_dpp v73, v73, v73 row_ror:1 row_mask:0xf bank_mask:0xf
    v_add_f32_dpp v74, v74, v74 row_ror:1 row_mask:0xf bank_mask:0xf
    v_add_f32_dpp v75, v75, v75 row_ror:1 row_mask:0xf bank_mask:0xf
    v_lshlrev_b32 v7, 3, v7
    v_add_u32 v7, 65536, v7
    v_and_b32 v6, 15, v0
    v_cmp_eq_u32 vcc, 0, v6
    v_mul_f32 v72, 0x3acccccd, v72
    v_mul_f32 v73, 0x3acccccd, v73
    v_fma_f32 v73, -v72, v72, v73
    v_max_f32 v73, 0, v73
    v_add_f32 v73, 0x3727c5ac, v73
    v_rsq_f32 v76, v73
    v_mul_f32 v77, -1.0, v72
    v_mul_f32 v77, v77, v76
    v_mul_f32 v74, 0x3acccccd, v74
    v_mul_f32 v75, 0x3acccccd, v75
    v_fma_f32 v75, -v74, v74, v75
    v_max_f32 v75, 0, v75
    v_add_f32 v75, 0x3727c5ac, v75
    v_rsq_f32 v78, v75
    v_mul_f32 v79, -1.0, v74
    v_mul_f32 v79, v79, v78
    s_and_saveexec_b64 s[58:59], vcc
    buffer_store_dwordx2 v[76:77], v7, s[32:35], 0 offen sc1
    buffer_store_dwordx2 v[78:79], v7, s[32:35], 0 offen offset:32 sc1
    s_mov_b64 exec, s[58:59]
L_nostat_31:
    s_mov_b32 s51, 0
L_X1LOOP:
    s_cmp_eq_u32 s51, 1
    s_cbranch_scc1 L_34
    s_cmp_eq_u32 s51, 9
    s_cbranch_scc1 L_35
    s_branch L_32
L_35:
    s_waitcnt vmcnt(0)
    s_branch L_32
L_34:
    s_waitcnt vmcnt(0)
L_32:
    s_barrier
    s_cmp_lg_u32 s51, 7
    s_cbranch_scc1 L_33
    s_lshl_b32 s52, s43, 3
    s_add_u32 s52, s52, 65536
    v_lshlrev_b32 v2, 4, v0
    s_mov_b32 m0, 69632
    s_nop 0
    buffer_load_dwordx4 v2, s[32:35], s52 offen sc1 lds
    s_lshl_b32 s52, s44, 2
    s_add_u32 s52, s52, 81920
    s_mov_b32 m0, 70656
    s_mov_b32 exec_hi, 0
    buffer_load_dwordx4 v2, s[32:35], s52 offen sc1 lds
    s_mov_b64 exec, -1
L_33:
    s_add_u32 s51, s51, 1
    s_cmp_lt_u32 s51, 10
    s_cbranch_scc1 L_X1LOOP
    s_barrier
    s_branch L_P2
L_C1:
    v_and_b32 v1, 31, v0
    v_lshrrev_b32 v2, 5, v0
    v_bfe_u32 v3, v0, 1, 3
    v_xor_b32 v3, v3, v2
    v_lshlrev_b32 v3, 4, v3
    s_lshr_b32 s52, s42, 1
    s_lshl_b32 s52, s52, 13
    v_lshl_add_u32 v3, v1, 7, v3
    v_add_u32 v16, s52, v3
    v_xor_b32 v17, 32, v16
    v_xor_b32 v18, 64, v16
    v_xor_b32 v19, 96, v16
    v_bfe_u32 v3, v0, 2, 2
    v_lshl_add_u32 v4, v2, 3, v3
    v_lshlrev_b32 v4, 8, v4
    v_bfe_u32 v5, v0, 4, 1
    v_lshlrev_b32 v5, 1, v5
    v_bfe_u32 v6, v0, 1, 1
    v_or_b32 v5, v5, v6
    s_and_b32 s52, s42, 1
    s_lshl_b32 s52, s52, 3
    v_or_b32 v5, s52, v5
    v_lshlrev_b32 v6, 2, v3
    v_xor_b32 v5, v5, v6
    v_lshl_add_u32 v4, v5, 4, v4
    v_and_b32 v6, 1, v0
    v_lshl_add_u32 v4, v6, 3, v4
    v_add_u32 v20, 16384, v4
    v_xor_b32 v21, 64, v20
    v_mov_b64 v[64:65], 0
    v_mov_b64 v[66:67], 0
    v_mov_b64 v[68:69], 0
    v_mov_b64 v[70:71], 0
    v_mov_b64 v[72:73], 0
    v_mov_b64 v[74:75], 0
    v_mov_b64 v[76:77], 0
    v_mov_b64 v[78:79], 0
    v_mov_b64 v[80:81], 0
    v_mov_b64 v[82:83], 0
    v_mov_b64 v[84:85], 0
    v_mov_b64 v[86:87], 0
    v_mov_b64 v[88:89], 0
    v_mov_b64 v[90:91], 0
    v_mov_b64 v[92:93], 0
    v_mov_b64 v[94:95], 0
    v_mov_b64 v[96:97], 0
    v_mov_b64 v[98:99], 0
    v_mov_b64 v[100:101], 0
    v_mov_b64 v[102:103], 0
    v_mov_b64 v[104:105], 0
    v_mov_b64 v[106:107], 0
    v_mov_b64 v[108:109], 0
    v_mov_b64 v[110:111], 0
    v_mov_b64 v[112:113], 0
    v_mov_b64 v[114:115], 0
    v_mov_b64 v[116:117], 0
    v_mov_b64 v[118:119], 0
    v_mov_b64 v[120:121], 0
    v_mov_b64 v[122:123], 0
    v_mov_b64 v[124:125], 0
    v_mov_b64 v[126:127], 0
    s_lshr_b32 s52, s42, 1
    s_lshl_b32 s52, s52, 6
    s_add_u32 s52, s52, s43
    v_and_b32 v1, 31, v0
    v_add_u32 v2, s52, v1
    s_lshr_b32 s63, s42, 1
    s_lshl_b32 s63, s63, 9
    s_add_u32 s63, s63, 69632
    v_lshlrev_b32 v61, 3, v1
    v_add_u32 v61, s63, v61
    s_and_b32 s53, s42, 1
    s_lshl_b32 s53, s53, 6
    s_add_u32 s53, s53, s44
    v_lshrrev_b32 v4, 5, v0
    v_lshlrev_b32 v62, 4, v4
    s_and_b32 s52, s42, 1
    s_lshl_b32 s52, s52, 8
    s_add_u32 s52, s52, 70656
    v_add_u32 v62, s52, v62
    s_lshr_b32 s53, s53, 3
    v_add_u32 v5, s53, v4
    v_lshlrev_b32 v5, 15, v5
    v_lshl_add_u32 v5, v2, 4, v5
    v_add_u32 v60, 1048576, v5
    s_mov_b32 s49, 0
    s_mov_b32 s51, 0
    v_add_u32 v24, s49, v16
    v_add_u32 v25, s49, v17
    v_add_u32 v26, s49, v18
    v_add_u32 v27, s49, v19
    v_add_u32 v28, s49, v20
    v_add_u32 v29, s49, v21
    s_waitcnt lgkmcnt(0)
    s_barrier
    v_lshlrev_b32 v2, 7, v0
    s_cmp_ge_u32 s42, 2
    s_cbranch_scc1 L_tx_36
    s_mov_b32 s36, s6
    s_mov_b32 s37, s7
    s_mov_b32 s38, 2457600
    s_mov_b32 s39, 0x20000
    s_mul_i32 s52, s40, 30
    s_add_u32 s52, s52, s41
    s_mul_i32 s52, s52, 10240
    s_mul_i32 s53, s42, 5120
    s_add_u32 s52, s52, s53
    s_mov_b32 exec_hi, 0xff
    buffer_load_dword v250, v2, s[36:39], s52 offen
    s_mov_b32 exec_hi, -1
    s_branch L_ty_37
L_tx_36:
    s_mov_b32 s36, s4
    s_mov_b32 s37, s5
    s_mov_b32 s38, 2621440
    s_mov_b32 s39, 0x20000
    s_mul_i32 s52, s40, 327680
    s_mul_i32 s53, s41, 11008
    s_add_u32 s52, s52, s53
    s_and_b32 s53, s42, 1
    s_mul_i32 s53, s53, 5504
    s_add_u32 s52, s52, s53
    s_mov_b32 exec_hi, 0x7ff
    buffer_load_dword v250, v2, s[36:39], s52 offen
    s_mov_b32 exec_hi, -1
L_ty_37:
    s_cmp_lg_u32 s42, 3
    s_cbranch_scc1 L_tz_38
    s_mov_b32 s36, s8
    s_mov_b32 s37, s9
    s_mov_b32 s38, 819200
    s_mov_b32 s39, 0x20000
    s_mul_i32 s52, s40, 30
    s_add_u32 s52, s52, s41
    s_mul_i32 s52, s52, 3456
    s_mov_b32 exec_hi, 0
    buffer_load_dword v251, v2, s[36:39], s52 offen
    s_mov_b32 exec_hi, -1
L_tz_38:
    s_mov_b32 s32, s20
    s_mov_b32 s33, s21
    s_mov_b32 s34, 268435456
    s_mov_b32 s35, 0x20000
    s_barrier
    ds_read_b64_tr_b16 v[128:129], v28 offset:0
    ds_read_b64_tr_b16 v[130:131], v28 offset:1024
    ds_read_b128 v[144:147], v24 offset:0
    ds_read_b128 v[148:151], v24 offset:4096
    ds_read_b64_tr_b16 v[132:133], v29 offset:0
    ds_read_b64_tr_b16 v[134:135], v29 offset:1024
L_C1LOOP:
    s_waitcnt lgkmcnt(0)
    v_mfma_f32_32x32x16_bf16 v[64:79], v[128:131], v[144:147], v[64:79]
    ds_read_b64_tr_b16 v[136:137], v28 offset:4096
    ds_read_b64_tr_b16 v[138:139], v28 offset:5120
    v_mfma_f32_32x32x16_bf16 v[80:95], v[128:131], v[148:151], v[80:95]
    ds_read_b128 v[152:155], v25 offset:0
    ds_read_b128 v[156:159], v25 offset:4096
    v_mfma_f32_32x32x16_bf16 v[96:111], v[132:135], v[144:147], v[96:111]
    ds_read_b64_tr_b16 v[140:141], v29 offset:4096
    ds_read_b64_tr_b16 v[142:143], v29 offset:5120
    v_mfma_f32_32x32x16_bf16 v[112:127], v[132:135], v[148:151], v[112:127]
    s_waitcnt lgkmcnt(0)
    v_mfma_f32_32x32x16_bf16 v[64:79], v[136:139], v[152:155], v[64:79]
    ds_read_b64_tr_b16 v[128:129], v28 offset:8192
    ds_read_b64_tr_b16 v[130:131], v28 offset:9216
    v_mfma_f32_32x32x16_bf16 v[80:95], v[136:139], v[156:159], v[80:95]
    ds_read_b128 v[144:147], v26 offset:0
    ds_read_b128 v[148:151], v26 offset:4096
    v_mfma_f32_32x32x16_bf16 v[96:111], v[140:143], v[152:155], v[96:111]
    ds_read_b64_tr_b16 v[132:133], v29 offset:8192
    ds_read_b64_tr_b16 v[134:135], v29 offset:9216
    v_mfma_f32_32x32x16_bf16 v[112:127], v[140:143], v[156:159], v[112:127]
    s_waitcnt lgkmcnt(0)
    v_mfma_f32_32x32x16_bf16 v[64:79], v[128:131], v[144:147], v[64:79]
    ds_read_b64_tr_b16 v[136:137], v28 offset:12288
    ds_read_b64_tr_b16 v[138:139], v28 offset:13312
    v_mfma_f32_32x32x16_bf16 v[80:95], v[128:131], v[148:151], v[80:95]
    ds_read_b128 v[152:155], v27 offset:0
    ds_read_b128 v[156:159], v27 offset:4096
    v_mfma_f32_32x32x16_bf16 v[96:111], v[132:135], v[144:147], v[96:111]
    ds_read_b64_tr_b16 v[140:141], v29 offset:12288
    ds_read_b64_tr_b16 v[142:143], v29 offset:13312
    s_add_u32 s49, s49, 32768
    s_cmp_eq_u32 s49, 131072
    s_cselect_b32 s49, 0, s49
    v_mfma_f32_32x32x16_bf16 v[112:127], v[132:135], v[148:151], v[112:127]
    v_add_u32 v24, s49, v16
    v_add_u32 v25, s49, v17
    v_add_u32 v26, s49, v18
    v_add_u32 v27, s49, v19
    v_add_u32 v28, s49, v20
    v_add_u32 v29, s49, v21
    s_waitcnt lgkmcnt(0)
    s_barrier
    v_mfma_f32_32x32x16_bf16 v[64:79], v[136:139], v[152:155], v[64:79]
    ds_read_b64_tr_b16 v[128:129], v28 offset:0
    ds_read_b64_tr_b16 v[130:131], v28 offset:1024
    v_mfma_f32_32x32x16_bf16 v[80:95], v[136:139], v[156:159], v[80:95]
    ds_read_b128 v[144:147], v24 offset:0
    ds_read_b128 v[148:151], v24 offset:4096
    v_mfma_f32_32x32x16_bf16 v[96:111], v[140:143], v[152:155], v[96:111]
    ds_read_b64_tr_b16 v[132:133], v29 offset:0
    ds_read_b64_tr_b16 v[134:135], v29 offset:1024
    v_mfma_f32_32x32x16_bf16 v[112:127], v[140:143], v[156:159], v[112:127]
    s_add_u32 s51, s51, 1
    s_cmp_lt_u32 s51, 10
    s_cbranch_scc1 L_C1LOOP
    s_cmp_lt_u32 s46, 5
    s_cselect_b32 s52, 0x3ea52b48, 1.0
    ds_read_b64 v[56:57], v61
    ds_read_b64 v[58:59], v61 offset:256
    ds_read_b128 v[160:163], v62 offset:0
    ds_read_b128 v[164:167], v62 offset:32
    ds_read_b128 v[168:171], v62 offset:64
    ds_read_b128 v[172:175], v62 offset:96
    ds_read_b128 v[176:179], v62 offset:128
    ds_read_b128 v[180:183], v62 offset:160
    ds_read_b128 v[184:187], v62 offset:192
    ds_read_b128 v[188:191], v62 offset:224
    s_waitcnt lgkmcnt(0)
    v_mul_f32 v56, s52, v56
    v_mul_f32 v57, s52, v57
    v_mul_f32 v58, s52, v58
    v_mul_f32 v59, s52, v59
    v_pk_mul_f32 v[64:65], v[64:65], v[56:57] op_sel_hi:[1,0]
    v_pk_mul_f32 v[66:67], v[66:67], v[56:57] op_sel_hi:[1,0]
    v_pk_mul_f32 v[68:69], v[68:69], v[56:57] op_sel_hi:[1,0]
    v_pk_mul_f32 v[70:71], v[70:71], v[56:57] op_sel_hi:[1,0]
    v_pk_mul_f32 v[72:73], v[72:73], v[56:57] op_sel_hi:[1,0]
    v_pk_mul_f32 v[74:75], v[74:75], v[56:57] op_sel_hi:[1,0]
    v_pk_mul_f32 v[76:77], v[76:77], v[56:57] op_sel_hi:[1,0]
    v_pk_mul_f32 v[78:79], v[78:79], v[56:57] op_sel_hi:[1,0]
    v_pk_fma_f32 v[64:65], v[160:161], v[56:57], v[64:65] op_sel:[0,1,0] op_sel_hi:[1,1,1]
    v_pk_fma_f32 v[66:67], v[162:163], v[56:57], v[66:67] op_sel:[0,1,0] op_sel_hi:[1,1,1]
    v_pk_fma_f32 v[68:69], v[164:165], v[56:57], v[68:69] op_sel:[0,1,0] op_sel_hi:[1,1,1]
    v_pk_fma_f32 v[70:71], v[166:167], v[56:57], v[70:71] op_sel:[0,1,0] op_sel_hi:[1,1,1]
    v_pk_fma_f32 v[72:73], v[168:169], v[56:57], v[72:73] op_sel:[0,1,0] op_sel_hi:[1,1,1]
    v_pk_fma_f32 v[74:75], v[170:171], v[56:57], v[74:75] op_sel:[0,1,0] op_sel_hi:[1,1,1]
    v_pk_fma_f32 v[76:77], v[172:173], v[56:57], v[76:77] op_sel:[0,1,0] op_sel_hi:[1,1,1]
    v_pk_fma_f32 v[78:79], v[174:175], v[56:57], v[78:79] op_sel:[0,1,0] op_sel_hi:[1,1,1]
    v_cvt_pk_bf16_f32 v192, v64, v65
    v_cvt_pk_bf16_f32 v193, v66, v67
    v_cvt_pk_bf16_f32 v194, v68, v69
    v_cvt_pk_bf16_f32 v195, v70, v71
    s_nop 0
    v_permlane32_swap_b32 v192, v194
    v_permlane32_swap_b32 v193, v195
    s_mov_b32 s52, 0
    buffer_store_dwordx4 v[192:195], v60, s[32:35], s52 offen offset:0 sc1
    v_cvt_pk_bf16_f32 v196, v72, v73
    v_cvt_pk_bf16_f32 v197, v74, v75
    v_cvt_pk_bf16_f32 v198, v76, v77
    v_cvt_pk_bf16_f32 v199, v78, v79
    s_nop 0
    v_permlane32_swap_b32 v196, v198
    v_permlane32_swap_b32 v197, v199
    s_mov_b32 s52, 65536
    buffer_store_dwordx4 v[196:199], v60, s[32:35], s52 offen offset:0 sc1
    v_pk_mul_f32 v[80:81], v[80:81], v[58:59] op_sel_hi:[1,0]
    v_pk_mul_f32 v[82:83], v[82:83], v[58:59] op_sel_hi:[1,0]
    v_pk_mul_f32 v[84:85], v[84:85], v[58:59] op_sel_hi:[1,0]
    v_pk_mul_f32 v[86:87], v[86:87], v[58:59] op_sel_hi:[1,0]
    v_pk_mul_f32 v[88:89], v[88:89], v[58:59] op_sel_hi:[1,0]
    v_pk_mul_f32 v[90:91], v[90:91], v[58:59] op_sel_hi:[1,0]
    v_pk_mul_f32 v[92:93], v[92:93], v[58:59] op_sel_hi:[1,0]
    v_pk_mul_f32 v[94:95], v[94:95], v[58:59] op_sel_hi:[1,0]
    v_pk_fma_f32 v[80:81], v[160:161], v[58:59], v[80:81] op_sel:[0,1,0] op_sel_hi:[1,1,1]
    v_pk_fma_f32 v[82:83], v[162:163], v[58:59], v[82:83] op_sel:[0,1,0] op_sel_hi:[1,1,1]
    v_pk_fma_f32 v[84:85], v[164:165], v[58:59], v[84:85] op_sel:[0,1,0] op_sel_hi:[1,1,1]
    v_pk_fma_f32 v[86:87], v[166:167], v[58:59], v[86:87] op_sel:[0,1,0] op_sel_hi:[1,1,1]
    v_pk_fma_f32 v[88:89], v[168:169], v[58:59], v[88:89] op_sel:[0,1,0] op_sel_hi:[1,1,1]
    v_pk_fma_f32 v[90:91], v[170:171], v[58:59], v[90:91] op_sel:[0,1,0] op_sel_hi:[1,1,1]
    v_pk_fma_f32 v[92:93], v[172:173], v[58:59], v[92:93] op_sel:[0,1,0] op_sel_hi:[1,1,1]
    v_pk_fma_f32 v[94:95], v[174:175], v[58:59], v[94:95] op_sel:[0,1,0] op_sel_hi:[1,1,1]
    v_cvt_pk_bf16_f32 v200, v80, v81
    v_cvt_pk_bf16_f32 v201, v82, v83
    v_cvt_pk_bf16_f32 v202, v84, v85
    v_cvt_pk_bf16_f32 v203, v86, v87
    s_nop 0
    v_permlane32_swap_b32 v200, v202
    v_permlane32_swap_b32 v201, v203
    s_mov_b32 s52, 0
    buffer_store_dwordx4 v[200:203], v60, s[32:35], s52 offen offset:512 sc1
    v_cvt_pk_bf16_f32 v204, v88, v89
    v_cvt_pk_bf16_f32 v205, v90, v91
    v_cvt_pk_bf16_f32 v206, v92, v93
    v_cvt_pk_bf16_f32 v207, v94, v95
    s_nop 0
    v_permlane32_swap_b32 v204, v206
    v_permlane32_swap_b32 v205, v207
    s_mov_b32 s52, 65536
    buffer_store_dwordx4 v[204:207], v60, s[32:35], s52 offen offset:512 sc1
    v_pk_mul_f32 v[96:97], v[96:97], v[56:57] op_sel_hi:[1,0]
    v_pk_mul_f32 v[98:99], v[98:99], v[56:57] op_sel_hi:[1,0]
    v_pk_mul_f32 v[100:101], v[100:101], v[56:57] op_sel_hi:[1,0]
    v_pk_mul_f32 v[102:103], v[102:103], v[56:57] op_sel_hi:[1,0]
    v_pk_mul_f32 v[104:105], v[104:105], v[56:57] op_sel_hi:[1,0]
    v_pk_mul_f32 v[106:107], v[106:107], v[56:57] op_sel_hi:[1,0]
    v_pk_mul_f32 v[108:109], v[108:109], v[56:57] op_sel_hi:[1,0]
    v_pk_mul_f32 v[110:111], v[110:111], v[56:57] op_sel_hi:[1,0]
    v_pk_fma_f32 v[96:97], v[176:177], v[56:57], v[96:97] op_sel:[0,1,0] op_sel_hi:[1,1,1]
    v_pk_fma_f32 v[98:99], v[178:179], v[56:57], v[98:99] op_sel:[0,1,0] op_sel_hi:[1,1,1]
    v_pk_fma_f32 v[100:101], v[180:181], v[56:57], v[100:101] op_sel:[0,1,0] op_sel_hi:[1,1,1]
    v_pk_fma_f32 v[102:103], v[182:183], v[56:57], v[102:103] op_sel:[0,1,0] op_sel_hi:[1,1,1]
    v_pk_fma_f32 v[104:105], v[184:185], v[56:57], v[104:105] op_sel:[0,1,0] op_sel_hi:[1,1,1]
    v_pk_fma_f32 v[106:107], v[186:187], v[56:57], v[106:107] op_sel:[0,1,0] op_sel_hi:[1,1,1]
    v_pk_fma_f32 v[108:109], v[188:189], v[56:57], v[108:109] op_sel:[0,1,0] op_sel_hi:[1,1,1]
    v_pk_fma_f32 v[110:111], v[190:191], v[56:57], v[110:111] op_sel:[0,1,0] op_sel_hi:[1,1,1]
    v_cvt_pk_bf16_f32 v192, v96, v97
    v_cvt_pk_bf16_f32 v193, v98, v99
    v_cvt_pk_bf16_f32 v194, v100, v101
    v_cvt_pk_bf16_f32 v195, v102, v103
    s_nop 0
    v_permlane32_swap_b32 v192, v194
    v_permlane32_swap_b32 v193, v195
    s_mov_b32 s52, 131072
    buffer_store_dwordx4 v[192:195], v60, s[32:35], s52 offen offset:0 sc1
    v_cvt_pk_bf16_f32 v196, v104, v105
    v_cvt_pk_bf16_f32 v197, v106, v107
    v_cvt_pk_bf16_f32 v198, v108, v109
    v_cvt_pk_bf16_f32 v199, v110, v111
    s_nop 0
    v_permlane32_swap_b32 v196, v198
    v_permlane32_swap_b32 v197, v199
    s_mov_b32 s52, 196608
    buffer_store_dwordx4 v[196:199], v60, s[32:35], s52 offen offset:0 sc1
    v_pk_mul_f32 v[112:113], v[112:113], v[58:59] op_sel_hi:[1,0]
    v_pk_mul_f32 v[114:115], v[114:115], v[58:59] op_sel_hi:[1,0]
    v_pk_mul_f32 v[116:117], v[116:117], v[58:59] op_sel_hi:[1,0]
    v_pk_mul_f32 v[118:119], v[118:119], v[58:59] op_sel_hi:[1,0]
    v_pk_mul_f32 v[120:121], v[120:121], v[58:59] op_sel_hi:[1,0]
    v_pk_mul_f32 v[122:123], v[122:123], v[58:59] op_sel_hi:[1,0]
    v_pk_mul_f32 v[124:125], v[124:125], v[58:59] op_sel_hi:[1,0]
    v_pk_mul_f32 v[126:127], v[126:127], v[58:59] op_sel_hi:[1,0]
    v_pk_fma_f32 v[112:113], v[176:177], v[58:59], v[112:113] op_sel:[0,1,0] op_sel_hi:[1,1,1]
    v_pk_fma_f32 v[114:115], v[178:179], v[58:59], v[114:115] op_sel:[0,1,0] op_sel_hi:[1,1,1]
    v_pk_fma_f32 v[116:117], v[180:181], v[58:59], v[116:117] op_sel:[0,1,0] op_sel_hi:[1,1,1]
    v_pk_fma_f32 v[118:119], v[182:183], v[58:59], v[118:119] op_sel:[0,1,0] op_sel_hi:[1,1,1]
    v_pk_fma_f32 v[120:121], v[184:185], v[58:59], v[120:121] op_sel:[0,1,0] op_sel_hi:[1,1,1]
    v_pk_fma_f32 v[122:123], v[186:187], v[58:59], v[122:123] op_sel:[0,1,0] op_sel_hi:[1,1,1]
    v_pk_fma_f32 v[124:125], v[188:189], v[58:59], v[124:125] op_sel:[0,1,0] op_sel_hi:[1,1,1]
    v_pk_fma_f32 v[126:127], v[190:191], v[58:59], v[126:127] op_sel:[0,1,0] op_sel_hi:[1,1,1]
    v_cvt_pk_bf16_f32 v200, v112, v113
    v_cvt_pk_bf16_f32 v201, v114, v115
    v_cvt_pk_bf16_f32 v202, v116, v117
    v_cvt_pk_bf16_f32 v203, v118, v119
    s_nop 0
    v_permlane32_swap_b32 v200, v202
    v_permlane32_swap_b32 v201, v203
    s_mov_b32 s52, 131072
    buffer_store_dwordx4 v[200:203], v60, s[32:35], s52 offen offset:512 sc1
    v_cvt_pk_bf16_f32 v204, v120, v121
    v_cvt_pk_bf16_f32 v205, v122, v123
    v_cvt_pk_bf16_f32 v206, v124, v125
    v_cvt_pk_bf16_f32 v207, v126, v127
    s_nop 0
    v_permlane32_swap_b32 v204, v206
    v_permlane32_swap_b32 v205, v207
    s_mov_b32 s52, 196608
    buffer_store_dwordx4 v[204:207], v60, s[32:35], s52 offen offset:512 sc1
    s_waitcnt vmcnt(0)
    s_barrier
    s_branch L_P2
L_COLSUM:
    s_waitcnt lgkmcnt(0)
    s_mov_b32 s32, s20
    s_mov_b32 s33, s21
    s_mov_b32 s34, 268435456
    s_mov_b32 s35, 0x20000
    s_getreg_b32 s55, hwreg(HW_REG_XCC_ID, 0, 4)
    s_lshl_b32 s46, s40, 1
    s_add_u32 s46, s46, s41
    s_sub_u32 s46, s46, 30
    s_cmp_lg_u32 s42, 6
    s_cbranch_scc1 L_w_39
    v_mov_b32 v2, 0
    s_lshl_b32 s52, s2, 7
    v_mov_b32 v3, s52
    s_lshl_b32 s52, s40, 8
    s_lshl_b32 s53, s41, 2
    s_add_u32 s52, s52, s53
    s_add_u32 s52, s52, 32768
    v_mov_b32 v4, s52
    v_cmp_eq_u32 vcc, 0, v0
    s_nop 1
    v_cndmask_b32 v3, v4, v3, vcc
    s_mov_b64 exec, 3
    buffer_store_dword v2, v3, s[32:35], 0 offen sc1
    s_mov_b64 exec, -1
    s_waitcnt vmcnt(0)
    s_lshl_b32 s52, s40, 5
    s_add_u32 s52, s52, s41
    s_and_b32 s53, s52, 3
    s_lshl_b32 s53, s53, 3
    s_and_b32 s52, s52, 0xfc
    s_or_b32 s63, s55, 0x80
    s_lshl_b32 s63, s63, s53
    s_atomic_or s63, s[18:19], s52
L_w_39:
    s_mov_b32 s50, 0
    s_cmp_ge_u32 s46, 15
    s_cbranch_scc1 L_CS_DONE
    s_lshl_b32 s52, s46, 8
    s_add_u32 s28, s6, s52
    s_addc_u32 s29, s7, 0
    s_sub_u32 s30, 2457600, s52
    s_mov_b32 s31, 0x20000
    s_mov_b32 s44, 3840
    s_mov_b32 s45, 81920
    s_branch L_CS_BODY
L_CS1:
    s_lshl_b32 s46, s40, 1
    s_add_u32 s46, s46, s41
    s_sub_u32 s46, s46, 30
    s_mov_b32 s50, 1
    s_cmp_ge_u32 s46, 12
    s_cbranch_scc1 L_CS_DONE
    s_lshl_b32 s52, s46, 8
    s_add_u32 s28, s12, s52
    s_addc_u32 s29, s13, 0
    s_sub_u32 s30, 1966080, s52
    s_mov_b32 s31, 0x20000
    s_mov_b32 s44, 3072
    s_mov_b32 s45, 90112
L_CS_BODY:
    v_lshrrev_b32 v1, 4, v0
    s_lshl_b32 s52, s42, 2
    v_add_u32 v1, s52, v1
    v_mul_lo_u32 v2, v1, s44
    v_and_b32 v3, 15, v0
    v_lshl_add_u32 v2, v3, 4, v2
    v_mov_b32 v8, 0
    v_mov_b32 v9, 0
    v_mov_b32 v10, 0
    v_mov_b32 v11, 0
    v_mov_b32 v12, 0
    v_mov_b32 v13, 0
    v_mov_b32 v14, 0
    v_mov_b32 v15, 0
    s_mov_b32 s48, 0
    s_lshl_b32 s47, s44, 5
    buffer_load_dwordx4 v[32:35], v2, s[28:31], s48 offen
    s_add_u32 s48, s48, s47
    buffer_load_dwordx4 v[36:39], v2, s[28:31], s48 offen
    s_add_u32 s48, s48, s47
    buffer_load_dwordx4 v[40:43], v2, s[28:31], s48 offen
    s_add_u32 s48, s48, s47
    buffer_load_dwordx4 v[44:47], v2, s[28:31], s48 offen
    s_add_u32 s48, s48, s47
    buffer_load_dwordx4 v[48:51], v2, s[28:31], s48 offen
    s_add_u32 s48, s48, s47
    buffer_load_dwordx4 v[52:55], v2, s[28:31], s48 offen
    s_add_u32 s48, s48, s47
    buffer_load_dwordx4 v[56:59], v2, s[28:31], s48 offen
    s_add_u32 s48, s48, s47
    buffer_load_dwordx4 v[60:63], v2, s[28:31], s48 offen
    s_add_u32 s48, s48, s47
    buffer_load_dwordx4 v[64:67], v2, s[28:31], s48 offen
    s_add_u32 s48, s48, s47
    buffer_load_dwordx4 v[68:71], v2, s[28:31], s48 offen
    s_add_u32 s48, s48, s47
    buffer_load_dwordx4 v[72:75], v2, s[28:31], s48 offen
    s_add_u32 s48, s48, s47
    buffer_load_dwordx4 v[76:79], v2, s[28:31], s48 offen
    s_add_u32 s48, s48, s47
    buffer_load_dwordx4 v[80:83], v2, s[28:31], s48 offen
    s_add_u32 s48, s48, s47
    buffer_load_dwordx4 v[84:87], v2, s[28:31], s48 offen
    s_add_u32 s48, s48, s47
    buffer_load_dwordx4 v[88:91], v2, s[28:31], s48 offen
    s_add_u32 s48, s48, s47
    buffer_load_dwordx4 v[92:95], v2, s[28:31], s48 offen
    s_add_u32 s48, s48, s47
    buffer_load_dwordx4 v[96:99], v2, s[28:31], s48 offen
    s_add_u32 s48, s48, s47
    buffer_load_dwordx4 v[100:103], v2, s[28:31], s48 offen
    s_add_u32 s48, s48, s47
    buffer_load_dwordx4 v[104:107], v2, s[28:31], s48 offen
    s_add_u32 s48, s48, s47
    buffer_load_dwordx4 v[108:111], v2, s[28:31], s48 offen
    s_add_u32 s48, s48, s47
    s_waitcnt vmcnt(16)
    v_lshlrev_b32 v4, 16, v32
    v_and_b32 v5, 0xffff0000, v32
    v_add_f32 v8, v8, v4
    v_add_f32 v9, v9, v5
    v_lshlrev_b32 v4, 16, v33
    v_and_b32 v5, 0xffff0000, v33
    v_add_f32 v10, v10, v4
    v_add_f32 v11, v11, v5
    v_lshlrev_b32 v4, 16, v34
    v_and_b32 v5, 0xffff0000, v34
    v_add_f32 v12, v12, v4
    v_add_f32 v13, v13, v5
    v_lshlrev_b32 v4, 16, v35
    v_and_b32 v5, 0xffff0000, v35
    v_add_f32 v14, v14, v4
    v_add_f32 v15, v15, v5
    v_lshlrev_b32 v4, 16, v36
    v_and_b32 v5, 0xffff0000, v36
    v_add_f32 v8, v8, v4
    v_add_f32 v9, v9, v5
    v_lshlrev_b32 v4, 16, v37
    v_and_b32 v5, 0xffff0000, v37
    v_add_f32 v10, v10, v4
    v_add_f32 v11, v11, v5
    v_lshlrev_b32 v4, 16, v38
    v_and_b32 v5, 0xffff0000, v38
    v_add_f32 v12, v12, v4
    v_add_f32 v13, v13, v5
    v_lshlrev_b32 v4, 16, v39
    v_and_b32 v5, 0xffff0000, v39
    v_add_f32 v14, v14, v4
    v_add_f32 v15, v15, v5
    v_lshlrev_b32 v4, 16, v40
    v_and_b32 v5, 0xffff0000, v40
    v_add_f32 v8, v8, v4
    v_add_f32 v9, v9, v5
    v_lshlrev_b32 v4, 16, v41
    v_and_b32 v5, 0xffff0000, v41
    v_add_f32 v10, v10, v4
    v_add_f32 v11, v11, v5
    v_lshlrev_b32 v4, 16, v42
    v_and_b32 v5, 0xffff0000, v42
    v_add_f32 v12, v12, v4
    v_add_f32 v13, v13, v5
    v_lshlrev_b32 v4, 16, v43
    v_and_b32 v5, 0xffff0000, v43
    v_add_f32 v14, v14, v4
    v_add_f32 v15, v15, v5
    v_lshlrev_b32 v4, 16, v44
    v_and_b32 v5, 0xffff0000, v44
    v_add_f32 v8, v8, v4
    v_add_f32 v9, v9, v5
    v_lshlrev_b32 v4, 16, v45
    v_and_b32 v5, 0xffff0000, v45
    v_add_f32 v10, v10, v4
    v_add_f32 v11, v11, v5
    v_lshlrev_b32 v4, 16, v46
    v_and_b32 v5, 0xffff0000, v46
    v_add_f32 v12, v12, v4
    v_add_f32 v13, v13, v5
    v_lshlrev_b32 v4, 16, v47
    v_and_b32 v5, 0xffff0000, v47
    v_add_f32 v14, v14, v4
    v_add_f32 v15, v15, v5
    s_waitcnt vmcnt(12)
    v_lshlrev_b32 v4, 16, v48
    v_and_b32 v5, 0xffff0000, v48
    v_add_f32 v8, v8, v4
    v_add_f32 v9, v9, v5
    v_lshlrev_b32 v4, 16, v49
    v_and_b32 v5, 0xffff0000, v49
    v_add_f32 v10, v10, v4
    v_add_f32 v11, v11, v5
    v_lshlrev_b32 v4, 16, v50
    v_and_b32 v5, 0xffff0000, v50
    v_add_f32 v12, v12, v4
    v_add_f32 v13, v13, v5
    v_lshlrev_b32 v4, 16, v51
    v_and_b32 v5, 0xffff0000, v51
    v_add_f32 v14, v14, v4
    v_add_f32 v15, v15, v5
    v_lshlrev_b32 v4, 16, v52
    v_and_b32 v5, 0xffff0000, v52
    v_add_f32 v8, v8, v4
    v_add_f32 v9, v9, v5
    v_lshlrev_b32 v4, 16, v53
    v_and_b32 v5, 0xffff0000, v53
    v_add_f32 v10, v10, v4
    v_add_f32 v11, v11, v5
    v_lshlrev_b32 v4, 16, v54
    v_and_b32 v5, 0xffff0000, v54
    v_add_f32 v12, v12, v4
    v_add_f32 v13, v13, v5
    v_lshlrev_b32 v4, 16, v55
    v_and_b32 v5, 0xffff0000, v55
    v_add_f32 v14, v14, v4
    v_add_f32 v15, v15, v5
    v_lshlrev_b32 v4, 16, v56
    v_and_b32 v5, 0xffff0000, v56
    v_add_f32 v8, v8, v4
    v_add_f32 v9, v9, v5
    v_lshlrev_b32 v4, 16, v57
    v_and_b32 v5, 0xffff0000, v57
    v_add_f32 v10, v10, v4
    v_add_f32 v11, v11, v5
    v_lshlrev_b32 v4, 16, v58
    v_and_b32 v5, 0xffff0000, v58
    v_add_f32 v12, v12, v4
    v_add_f32 v13, v13, v5
    v_lshlrev_b32 v4, 16, v59
    v_and_b32 v5, 0xffff0000, v59
    v_add_f32 v14, v14, v4
    v_add_f32 v15, v15, v5
    v_lshlrev_b32 v4, 16, v60
    v_and_b32 v5, 0xffff0000, v60
    v_add_f32 v8, v8, v4
    v_add_f32 v9, v9, v5
    v_lshlrev_b32 v4, 16, v61
    v_and_b32 v5, 0xffff0000, v61
    v_add_f32 v10, v10, v4
    v_add_f32 v11, v11, v5
    v_lshlrev_b32 v4, 16, v62
    v_and_b32 v5, 0xffff0000, v62
    v_add_f32 v12, v12, v4
    v_add_f32 v13, v13, v5
    v_lshlrev_b32 v4, 16, v63
    v_and_b32 v5, 0xffff0000, v63
    v_add_f32 v14, v14, v4
    v_add_f32 v15, v15, v5
    s_waitcnt vmcnt(8)
    v_lshlrev_b32 v4, 16, v64
    v_and_b32 v5, 0xffff0000, v64
    v_add_f32 v8, v8, v4
    v_add_f32 v9, v9, v5
    v_lshlrev_b32 v4, 16, v65
    v_and_b32 v5, 0xffff0000, v65
    v_add_f32 v10, v10, v4
    v_add_f32 v11, v11, v5
    v_lshlrev_b32 v4, 16, v66
    v_and_b32 v5, 0xffff0000, v66
    v_add_f32 v12, v12, v4
    v_add_f32 v13, v13, v5
    v_lshlrev_b32 v4, 16, v67
    v_and_b32 v5, 0xffff0000, v67
    v_add_f32 v14, v14, v4
    v_add_f32 v15, v15, v5
    v_lshlrev_b32 v4, 16, v68
    v_and_b32 v5, 0xffff0000, v68
    v_add_f32 v8, v8, v4
    v_add_f32 v9, v9, v5
    v_lshlrev_b32 v4, 16, v69
    v_and_b32 v5, 0xffff0000, v69
    v_add_f32 v10, v10, v4
    v_add_f32 v11, v11, v5
    v_lshlrev_b32 v4, 16, v70
    v_and_b32 v5, 0xffff0000, v70
    v_add_f32 v12, v12, v4
    v_add_f32 v13, v13, v5
    v_lshlrev_b32 v4, 16, v71
    v_and_b32 v5, 0xffff0000, v71
    v_add_f32 v14, v14, v4
    v_add_f32 v15, v15, v5
    v_lshlrev_b32 v4, 16, v72
    v_and_b32 v5, 0xffff0000, v72
    v_add_f32 v8, v8, v4
    v_add_f32 v9, v9, v5
    v_lshlrev_b32 v4, 16, v73
    v_and_b32 v5, 0xffff0000, v73
    v_add_f32 v10, v10, v4
    v_add_f32 v11, v11, v5
    v_lshlrev_b32 v4, 16, v74
    v_and_b32 v5, 0xffff0000, v74
    v_add_f32 v12, v12, v4
    v_add_f32 v13, v13, v5
    v_lshlrev_b32 v4, 16, v75
    v_and_b32 v5, 0xffff0000, v75
    v_add_f32 v14, v14, v4
    v_add_f32 v15, v15, v5
    v_lshlrev_b32 v4, 16, v76
    v_and_b32 v5, 0xffff0000, v76
    v_add_f32 v8, v8, v4
    v_add_f32 v9, v9, v5
    v_lshlrev_b32 v4, 16, v77
    v_and_b32 v5, 0xffff0000, v77
    v_add_f32 v10, v10, v4
    v_add_f32 v11, v11, v5
    v_lshlrev_b32 v4, 16, v78
    v_and_b32 v5, 0xffff0000, v78
    v_add_f32 v12, v12, v4
    v_add_f32 v13, v13, v5
    v_lshlrev_b32 v4, 16, v79
    v_and_b32 v5, 0xffff0000, v79
    v_add_f32 v14, v14, v4
    v_add_f32 v15, v15, v5
    s_waitcnt vmcnt(4)
    v_lshlrev_b32 v4, 16, v80
    v_and_b32 v5, 0xffff0000, v80
    v_add_f32 v8, v8, v4
    v_add_f32 v9, v9, v5
    v_lshlrev_b32 v4, 16, v81
    v_and_b32 v5, 0xffff0000, v81
    v_add_f32 v10, v10, v4
    v_add_f32 v11, v11, v5
    v_lshlrev_b32 v4, 16, v82
    v_and_b32 v5, 0xffff0000, v82
    v_add_f32 v12, v12, v4
    v_add_f32 v13, v13, v5
    v_lshlrev_b32 v4, 16, v83
    v_and_b32 v5, 0xffff0000, v83
    v_add_f32 v14, v14, v4
    v_add_f32 v15, v15, v5
    v_lshlrev_b32 v4, 16, v84
    v_and_b32 v5, 0xffff0000, v84
    v_add_f32 v8, v8, v4
    v_add_f32 v9, v9, v5
    v_lshlrev_b32 v4, 16, v85
    v_and_b32 v5, 0xffff0000, v85
    v_add_f32 v10, v10, v4
    v_add_f32 v11, v11, v5
    v_lshlrev_b32 v4, 16, v86
    v_and_b32 v5, 0xffff0000, v86
    v_add_f32 v12, v12, v4
    v_add_f32 v13, v13, v5
    v_lshlrev_b32 v4, 16, v87
    v_and_b32 v5, 0xffff0000, v87
    v_add_f32 v14, v14, v4
    v_add_f32 v15, v15, v5
    v_lshlrev_b32 v4, 16, v88
    v_and_b32 v5, 0xffff0000, v88
    v_add_f32 v8, v8, v4
    v_add_f32 v9, v9, v5
    v_lshlrev_b32 v4, 16, v89
    v_and_b32 v5, 0xffff0000, v89
    v_add_f32 v10, v10, v4
    v_add_f32 v11, v11, v5
    v_lshlrev_b32 v4, 16, v90
    v_and_b32 v5, 0xffff0000, v90
    v_add_f32 v12, v12, v4
    v_add_f32 v13, v13, v5
    v_lshlrev_b32 v4, 16, v91
    v_and_b32 v5, 0xffff0000, v91
    v_add_f32 v14, v14, v4
    v_add_f32 v15, v15, v5
    v_lshlrev_b32 v4, 16, v92
    v_and_b32 v5, 0xffff0000, v92
    v_add_f32 v8, v8, v4
    v_add_f32 v9, v9, v5
    v_lshlrev_b32 v4, 16, v93
    v_and_b32 v5, 0xffff0000, v93
    v_add_f32 v10, v10, v4
    v_add_f32 v11, v11, v5
    v_lshlrev_b32 v4, 16, v94
    v_and_b32 v5, 0xffff0000, v94
    v_add_f32 v12, v12, v4
    v_add_f32 v13, v13, v5
    v_lshlrev_b32 v4, 16, v95
    v_and_b32 v5, 0xffff0000, v95
    v_add_f32 v14, v14, v4
    v_add_f32 v15, v15, v5
    s_waitcnt vmcnt(0)
    v_lshlrev_b32 v4, 16, v96
    v_and_b32 v5, 0xffff0000, v96
    v_add_f32 v8, v8, v4
    v_add_f32 v9, v9, v5
    v_lshlrev_b32 v4, 16, v97
    v_and_b32 v5, 0xffff0000, v97
    v_add_f32 v10, v10, v4
    v_add_f32 v11, v11, v5
    v_lshlrev_b32 v4, 16, v98
    v_and_b32 v5, 0xffff0000, v98
    v_add_f32 v12, v12, v4
    v_add_f32 v13, v13, v5
    v_lshlrev_b32 v4, 16, v99
    v_and_b32 v5, 0xffff0000, v99
    v_add_f32 v14, v14, v4
    v_add_f32 v15, v15, v5
    v_lshlrev_b32 v4, 16, v100
    v_and_b32 v5, 0xffff0000, v100
    v_add_f32 v8, v8, v4
    v_add_f32 v9, v9, v5
    v_lshlrev_b32 v4, 16, v101
    v_and_b32 v5, 0xffff0000, v101
    v_add_f32 v10, v10, v4
    v_add_f32 v11, v11, v5
    v_lshlrev_b32 v4, 16, v102
    v_and_b32 v5, 0xffff0000, v102
    v_add_f32 v12, v12, v4
    v_add_f32 v13, v13, v5
    v_lshlrev_b32 v4, 16, v103
    v_and_b32 v5, 0xffff0000, v103
    v_add_f32 v14, v14, v4
    v_add_f32 v15, v15, v5
    v_lshlrev_b32 v4, 16, v104
    v_and_b32 v5, 0xffff0000, v104
    v_add_f32 v8, v8, v4
    v_add_f32 v9, v9, v5
    v_lshlrev_b32 v4, 16, v105
    v_and_b32 v5, 0xffff0000, v105
    v_add_f32 v10, v10, v4
    v_add_f32 v11, v11, v5
    v_lshlrev_b32 v4, 16, v106
    v_and_b32 v5, 0xffff0000, v106
    v_add_f32 v12, v12, v4
    v_add_f32 v13, v13, v5
    v_lshlrev_b32 v4, 16, v107
    v_and_b32 v5, 0xffff0000, v107
    v_add_f32 v14, v14, v4
    v_add_f32 v15, v15, v5
    v_lshlrev_b32 v4, 16, v108
    v_and_b32 v5, 0xffff0000, v108
    v_add_f32 v8, v8, v4
    v_add_f32 v9, v9, v5
    v_lshlrev_b32 v4, 16, v109
    v_and_b32 v5, 0xffff0000, v109
    v_add_f32 v10, v10, v4
    v_add_f32 v11, v11, v5
    v_lshlrev_b32 v4, 16, v110
    v_and_b32 v5, 0xffff0000, v110
    v_add_f32 v12, v12, v4
    v_add_f32 v13, v13, v5
    v_lshlrev_b32 v4, 16, v111
    v_and_b32 v5, 0xffff0000, v111
    v_add_f32 v14, v14, v4
    v_add_f32 v15, v15, v5
    v_lshlrev_b32 v4, 9, v1
    v_lshl_add_u32 v4, v3, 5, v4
    ds_write_b128 v4, v[8:11]
    ds_write_b128 v4, v[12:15] offset:16
    s_waitcnt lgkmcnt(0)
    s_barrier
    s_cmp_ge_u32 s42, 2
    s_cbranch_scc1 L_w_40
    s_lshl_b32 s52, s42, 6
    v_add_u32 v1, s52, v0
    v_lshlrev_b32 v2, 2, v1
    ds_read_b32 v32, v2 offset:0
    ds_read_b32 v33, v2 offset:512
    ds_read_b32 v34, v2 offset:1024
    ds_read_b32 v35, v2 offset:1536
    ds_read_b32 v36, v2 offset:2048
    ds_read_b32 v37, v2 offset:2560
    ds_read_b32 v38, v2 offset:3072
    ds_read_b32 v39, v2 offset:3584
    ds_read_b32 v40, v2 offset:4096
    ds_read_b32 v41, v2 offset:4608
    ds_read_b32 v42, v2 offset:5120
    ds_read_b32 v43, v2 offset:5632
    ds_read_b32 v44, v2 offset:6144
    ds_read_b32 v45, v2 offset:6656
    ds_read_b32 v46, v2 offset:7168
    ds_read_b32 v47, v2 offset:7680
    ds_read_b32 v48, v2 offset:8192
    ds_read_b32 v49, v2 offset:8704
    ds_read_b32 v50, v2 offset:9216
    ds_read_b32 v51, v2 offset:9728
    ds_read_b32 v52, v2 offset:10240
    ds_read_b32 v53, v2 offset:10752
    ds_read_b32 v54, v2 offset:11264
    ds_read_b32 v55, v2 offset:11776
    ds_read_b32 v56, v2 offset:12288
    ds_read_b32 v57, v2 offset:12800
    ds_read_b32 v58, v2 offset:13312
    ds_read_b32 v59, v2 offset:13824
    ds_read_b32 v60, v2 offset:14336
    ds_read_b32 v61, v2 offset:14848
    ds_read_b32 v62, v2 offset:15360
    ds_read_b32 v63, v2 offset:15872
    s_waitcnt lgkmcnt(0)
    v_add_f32 v32, v32, v33
    v_add_f32 v32, v32, v34
    v_add_f32 v32, v32, v35
    v_add_f32 v32, v32, v36
    v_add_f32 v32, v32, v37
    v_add_f32 v32, v32, v38
    v_add_f32 v32, v32, v39
    v_add_f32 v32, v32, v40
    v_add_f32 v32, v32, v41
    v_add_f32 v32, v32, v42
    v_add_f32 v32, v32, v43
    v_add_f32 v32, v32, v44
    v_add_f32 v32, v32, v45
    v_add_f32 v32, v32, v46
    v_add_f32 v32, v32, v47
    v_add_f32 v32, v32, v48
    v_add_f32 v32, v32, v49
    v_add_f32 v32, v32, v50
    v_add_f32 v32, v32, v51
    v_add_f32 v32, v32, v52
    v_add_f32 v32, v32, v53
    v_add_f32 v32, v32, v54
    v_add_f32 v32, v32, v55
    v_add_f32 v32, v32, v56
    v_add_f32 v32, v32, v57
    v_add_f32 v32, v32, v58
    v_add_f32 v32, v32, v59
    v_add_f32 v32, v32, v60
    v_add_f32 v32, v32, v61
    v_add_f32 v32, v32, v62
    v_add_f32 v32, v32, v63
    s_lshl_b32 s52, s46, 9
    s_add_u32 s52, s52, s45
    v_add_u32 v2, s52, v2
    buffer_store_dword v32, v2, s[32:35], 0 offen sc1
    s_waitcnt vmcnt(0)
L_w_40:
    s_barrier
L_CS_DONE:
    s_cmp_lg_u32 s42, 6
    s_cbranch_scc1 L_w_41
    s_cmp_eq_u32 s50, 1
    s_cbranch_scc1 L_w_42
    s_lshl_b32 s52, s2, 7
    v_mov_b32 v3, s52
    v_mov_b32 v2, 1
    s_mov_b64 exec, 1
    buffer_store_dword v2, v3, s[32:35], 0 offen sc1
    s_mov_b64 exec, -1
    s_lshl_b32 s52, s40, 5
    s_load_dwordx8 s[64:71], s[18:19], s52
    s_add_u32 s52, s40, 7
    s_and_b32 s52, s52, 7
    s_lshl_b32 s52, s52, 5
    s_load_dwordx8 s[72:79], s[18:19], s52
    s_lshr_b32 s52, s46, 1
    s_lshl_b32 s52, s52, 5
    s_add_u32 s52, s52, 28
    s_load_dword s80, s[18:19], s52
    s_branch L_hs_44
L_hs_43:
    s_sleep 8
    s_lshl_b32 s52, s40, 5
    s_load_dwordx8 s[64:71], s[18:19], s52 glc
    s_add_u32 s52, s40, 7
    s_and_b32 s52, s52, 7
    s_lshl_b32 s52, s52, 5
    s_load_dwordx8 s[72:79], s[18:19], s52 glc
    s_lshr_b32 s52, s46, 1
    s_lshl_b32 s52, s52, 5
    s_add_u32 s52, s52, 28
    s_load_dword s80, s[18:19], s52 glc
L_hs_44:
    s_or_b32 s54, s55, 0x80
    s_mul_i32 s54, s54, 0x01010101
    s_waitcnt lgkmcnt(0)
    s_or_b32 s52, s80, 0x00008080
    s_and_b32 s52, s52, s64
    s_and_b32 s52, s52, s65
    s_and_b32 s52, s52, s66
    s_and_b32 s52, s52, s67
    s_and_b32 s52, s52, s68
    s_and_b32 s52, s52, s69
    s_and_b32 s52, s52, s70
    s_and_b32 s52, s52, s71
    s_and_b32 s52, s52, s72
    s_and_b32 s52, s52, s73
    s_and_b32 s52, s52, s74
    s_and_b32 s52, s52, s75
    s_and_b32 s52, s52, s76
    s_and_b32 s52, s52, s77
    s_and_b32 s52, s52, s78
    s_and_b32 s52, s52, s79
    s_and_b32 s52, s52, 0x80808080
    s_cmp_eq_u32 s52, 0x80808080
    s_cbranch_scc0 L_hs_43
    s_mov_b32 s53, 0
    s_xor_b32 s63, s64, s54
    s_and_b32 s63, s63, 0xbfbfbfbf
    s_or_b32 s53, s53, s63
    s_xor_b32 s63, s65, s54
    s_and_b32 s63, s63, 0xbfbfbfbf
    s_or_b32 s53, s53, s63
    s_xor_b32 s63, s66, s54
    s_and_b32 s63, s63, 0xbfbfbfbf
    s_or_b32 s53, s53, s63
    s_xor_b32 s63, s67, s54
    s_and_b32 s63, s63, 0xbfbfbfbf
    s_or_b32 s53, s53, s63
    s_xor_b32 s63, s68, s54
    s_and_b32 s63, s63, 0xbfbfbfbf
    s_or_b32 s53, s53, s63
    s_xor_b32 s63, s69, s54
    s_and_b32 s63, s63, 0xbfbfbfbf
    s_or_b32 s53, s53, s63
    s_xor_b32 s63, s70, s54
    s_and_b32 s63, s63, 0xbfbfbfbf
    s_or_b32 s53, s53, s63
    s_xor_b32 s63, s71, s54
    s_and_b32 s63, s63, 0xbfbfbfbf
    s_or_b32 s53, s53, s63
    s_cmp_eq_u32 s53, 0
    s_cselect_b32 s56, 1, 0
    s_load_dwordx16 s[64:79], s[18:19], 0
    s_load_dwordx16 s[80:95], s[18:19], 64
    s_branch L_ha_46
L_ha_45:
    s_sleep 8
    s_load_dwordx16 s[64:79], s[18:19], 0 glc
    s_load_dwordx16 s[80:95], s[18:19], 64 glc
L_ha_46:
    s_waitcnt lgkmcnt(0)
    s_mov_b32 s52, 0x80808080
    s_and_b32 s52, s52, s64
    s_and_b32 s52, s52, s65
    s_and_b32 s52, s52, s66
    s_and_b32 s52, s52, s67
    s_and_b32 s52, s52, s68
    s_and_b32 s52, s52, s69
    s_and_b32 s52, s52, s70
    s_and_b32 s52, s52, s71
    s_and_b32 s52, s52, s72
    s_and_b32 s52, s52, s73
    s_and_b32 s52, s52, s74
    s_and_b32 s52, s52, s75
    s_and_b32 s52, s52, s76
    s_and_b32 s52, s52, s77
    s_and_b32 s52, s52, s78
    s_and_b32 s52, s52, s79
    s_and_b32 s52, s52, s80
    s_and_b32 s52, s52, s81
    s_and_b32 s52, s52, s82
    s_and_b32 s52, s52, s83
    s_and_b32 s52, s52, s84
    s_and_b32 s52, s52, s85
    s_and_b32 s52, s52, s86
    s_and_b32 s52, s52, s87
    s_and_b32 s52, s52, s88
    s_and_b32 s52, s52, s89
    s_and_b32 s52, s52, s90
    s_and_b32 s52, s52, s91
    s_and_b32 s52, s52, s92
    s_and_b32 s52, s52, s93
    s_and_b32 s52, s52, s94
    s_and_b32 s52, s52, s95
    s_cmp_eq_u32 s52, 0x80808080
    s_cbranch_scc0 L_ha_45
    s_load_dwordx16 s[64:79], s[18:19], 128
    s_load_dwordx16 s[80:95], s[18:19], 192
    s_branch L_ha_48
L_ha_47:
    s_sleep 8
    s_load_dwordx16 s[64:79], s[18:19], 128 glc
    s_load_dwordx16 s[80:95], s[18:19], 192 glc
L_ha_48:
    s_waitcnt lgkmcnt(0)
    s_mov_b32 s52, 0x80808080
    s_and_b32 s52, s52, s64
    s_and_b32 s52, s52, s65
    s_and_b32 s52, s52, s66
    s_and_b32 s52, s52, s67
    s_and_b32 s52, s52, s68
    s_and_b32 s52, s52, s69
    s_and_b32 s52, s52, s70
    s_and_b32 s52, s52, s71
    s_and_b32 s52, s52, s72
    s_and_b32 s52, s52, s73
    s_and_b32 s52, s52, s74
    s_and_b32 s52, s52, s75
    s_and_b32 s52, s52, s76
    s_and_b32 s52, s52, s77
    s_and_b32 s52, s52, s78
    s_and_b32 s52, s52, s79
    s_and_b32 s52, s52, s80
    s_and_b32 s52, s52, s81
    s_and_b32 s52, s52, s82
    s_and_b32 s52, s52, s83
    s_and_b32 s52, s52, s84
    s_and_b32 s52, s52, s85
    s_and_b32 s52, s52, s86
    s_and_b32 s52, s52, s87
    s_and_b32 s52, s52, s88
    s_and_b32 s52, s52, s89
    s_and_b32 s52, s52, s90
    s_and_b32 s52, s52, s91
    s_and_b32 s52, s52, s92
    s_and_b32 s52, s52, s93
    s_and_b32 s52, s52, s94
    s_and_b32 s52, s52, s95
    s_cmp_eq_u32 s52, 0x80808080
    s_cbranch_scc0 L_ha_47
    s_branch L_w_41
L_w_42:
    s_lshl_b32 s52, s2, 7
    v_mov_b32 v3, s52
    v_mov_b32 v2, 2
    s_mov_b64 exec, 1
    buffer_store_dword v2, v3, s[32:35], 0 offen sc1
    s_mov_b64 exec, -1
L_w_41:
    s_cmp_eq_u32 s50, 1
    s_cbranch_scc1 L_P4
    s_branch L_P2
L_P2:
    s_and_b32 s46, s41, 15
    s_lshr_b32 s45, s41, 4
    s_lshl_b32 s43, s40, 8
    s_lshl_b32 s52, s45, 7
    s_add_u32 s43, s43, s52
    s_and_b32 s47, s42, 3
    s_lshr_b32 s48, s42, 2
    s_cmp_ge_u32 s42, 6
    s_cbranch_scc1 L_no_49
    s_lshl_b32 s52, s42, 6
    s_add_u32 s52, s52, s43
    s_cmp_lt_u32 s52, 256
    s_cselect_b32 s52, 0, 0x3f80
    v_mov_b32 v2, s52
    v_mov_b32 v3, 0
    v_mov_b32 v4, s52
    v_mov_b32 v5, 0
    s_lshl_b32 s52, s42, 10
    s_add_u32 s52, s52, 62080
    v_lshl_add_u32 v6, v0, 4, s52
    ds_write_b128 v6, v[2:5]
L_no_49:
    v_and_b32 v1, 31, v0
    v_lshrrev_b32 v2, 5, v0
    s_lshl_b32 s52, s47, 5
    v_add_u32 v3, s52, v1
    v_lshlrev_b32 v3, 4, v3
    s_mul_i32 s52, s48, 3
    v_add_u32 v4, s52, v2
    v_mul_u32_u24 v4, 6208, v4
    v_add_u32 v72, v3, v4
    v_add_u32 v73, 12416, v3
    v_bfe_u32 v4, v0, 4, 1
    v_lshlrev_b32 v4, 2, v4
    v_and_b32 v5, 3, v0
    v_or_b32 v4, v4, v5
    s_mul_i32 s52, s48, 5
    v_add_u32 v5, s52, v4
    v_lshrrev_b32 v6, 1, v5
    v_mul_u32_u24 v6, 6208, v6
    v_and_b32 v5, 1, v5
    v_lshl_add_u32 v6, v5, 3, v6
    v_add_u32 v6, 31040, v6
    v_cmp_gt_u32 vcc, 5, v4
    v_mov_b32 v7, 62080
    s_nop 0
    v_cndmask_b32 v6, v7, v6, vcc
    v_bfe_u32 v5, v0, 2, 2
    v_lshl_add_u32 v5, v2, 2, v5
    s_lshl_b32 s52, s47, 5
    v_add_u32 v5, s52, v5
    v_lshl_add_u32 v74, v5, 4, v6
    s_lshl_b32 s52, s47, 5
    s_add_u32 s52, s52, s43
    v_add_u32 v3, s52, v1
    v_lshlrev_b32 v3, 4, v3
    s_mul_i32 s52, s46, 5
    s_mul_i32 s53, s48, 3
    s_add_u32 s53, s53, s52
    v_add_u32 v4, s53, v2
    v_lshlrev_b32 v4, 15, v4
    v_add_u32 v75, v3, v4
    v_add_u32 v75, 1048576, v75
    s_add_u32 s52, s52, 2
    s_lshl_b32 s52, s52, 15
    s_add_u32 s52, s52, 1048576
    v_add_u32 v76, s52, v3
    s_mul_i32 s52, s46, 5
    s_lshl_b32 s53, s48, 1
    s_add_u32 s53, s53, s52
    v_add_u32 v4, s53, v2
    v_lshlrev_b32 v4, 15, v4
    v_add_u32 v77, v3, v4
    v_add_u32 v77, 1048576, v77
    s_add_u32 s52, s52, 4
    s_lshl_b32 s52, s52, 15
    s_lshl_b32 s53, s48, 3
    s_add_u32 s52, s52, s53
    s_add_u32 s52, s52, 1048576
    v_add_u32 v78, s52, v3
    v_lshl_add_u32 v2, v0, 3, s42
    v_cmp_le_u32 vcc, 30, v2
    s_nop 1
    v_cndmask_b32 v3, 0, 1, vcc
    v_mul_u32_u24 v4, 30, v3
    v_sub_u32 v4, v2, v4
    v_mul_u32_u24 v5, 43, v4
    v_lshrrev_b32 v5, 8, v5
    v_mul_u32_u24 v6, 6, v5
    v_sub_u32 v6, v4, v6
    v_mul_u32_u24 v7, 5, v3
    v_add_u32 v7, v7, v5
    v_mul_u32_u24 v7, 6208, v7
    v_lshl_add_u32 v91, v6, 10, v7
    v_add_u32 v7, 1, v3
    v_mul_u32_u24 v7, 80, v7
    v_add_u32 v7, v7, v5
    s_mul_i32 s52, s46, 5
    v_add_u32 v7, s52, v7
    v_lshlrev_b32 v7, 15, v7
    s_sub_u32 s52, s43, 256
    v_lshl_add_u32 v6, v6, 6, s52
    v_lshl_add_u32 v7, v6, 4, v7
    v_add_u32 v7, 1048576, v7
    v_cmp_gt_i32 vcc, 0, v6
    v_mov_b32 v5, 0x7f000000
    s_nop 0
    v_cndmask_b32 v90, v7, v5, vcc
    s_nop 0
    v_readlane_b32 s66, v90, 0
    v_readlane_b32 s74, v91, 0
    v_readlane_b32 s67, v90, 1
    v_readlane_b32 s75, v91, 1
    v_readlane_b32 s68, v90, 2
    v_readlane_b32 s76, v91, 2
    v_readlane_b32 s69, v90, 3
    v_readlane_b32 s77, v91, 3
    v_readlane_b32 s70, v90, 4
    v_readlane_b32 s78, v91, 4
    v_readlane_b32 s71, v90, 5
    v_readlane_b32 s79, v91, 5
    v_readlane_b32 s72, v90, 6
    v_readlane_b32 s80, v91, 6
    v_readlane_b32 s73, v90, 7
    v_readlane_b32 s81, v91, 7
    s_cmp_lg_u32 s42, 6
    s_cbranch_scc1 L_ns_50
    v_mul_u32_u24 v2, 43, v0
    v_lshrrev_b32 v2, 8, v2
    v_mul_u32_u24 v3, 6, v2
    v_sub_u32 v3, v0, v3
    v_lshrrev_b32 v4, 1, v3
    v_and_b32 v3, 1, v3
    s_lshl_b32 s52, s40, 1
    s_add_u32 s52, s52, s45
    v_sub_u32 v5, s52, v4
    s_mul_i32 s52, s46, 5
    v_lshl_add_u32 v6, v3, 2, s52
    v_lshrrev_b32 v6, 4, v6
    v_mul_u32_u24 v7, 5, v2
    v_add_u32 v6, v6, v7
    v_and_b32 v7, 1, v5
    v_mul_u32_u24 v7, 15, v7
    v_add_u32 v6, v6, v7
    v_lshlrev_b32 v6, 3, v6
    v_ashrrev_i32 v7, 1, v5
    v_add_u32 v6, v6, v7
    v_lshlrev_b32 v8, 7, v6
    v_cmp_gt_u32 vcc, 18, v0
    v_cmp_le_i32 s[60:61], 0, v5
    s_nop 2
    s_and_b64 vcc, vcc, s[60:61]
    v_cmp_eq_u32 s[60:61], 0, v2
    v_cmp_lt_u32 s[58:59], 0, v4
    s_nop 2
    s_and_b64 s[60:61], s[60:61], s[58:59]
    s_andn2_b64 vcc, vcc, s[60:61]
    v_readlane_b32 s101, v8, 0
    s_nop 3
    v_mov_b32 v9, s101
    v_cndmask_b32 v8, v9, v8, vcc
    v_mov_b32 v9, 2
L_poll_52:
    buffer_load_dword v10, v8, s[32:35], 0 offen sc1
L_poll_53:
    s_waitcnt vmcnt(0)
    v_cmp_lt_u32 s[60:61], v10, v9
    s_nop 2
    s_cmp_eq_u64 s[60:61], 0
    s_cbranch_scc0 L_poll_52
    v_mov_b32 v2, s56
    v_mov_b32 v3, 71680
    ds_write_b32 v3, v2
    s_branch L_go_51
L_ns_50:
    s_cmp_ge_u32 s41, 30
    s_cbranch_scc1 L_wi_54
    s_mul_i32 s52, s41, 26
    s_lshr_b32 s52, s52, 8
    s_mul_i32 s52, s52, 10
    s_sub_u32 s52, s41, s52
    s_lshl_b32 s52, s52, 7
    s_add_u32 s28, s8, s52
    s_addc_u32 s29, s9, 0
    s_sub_u32 s30, 819200, s52
    s_mov_b32 s31, 0x20000
    v_lshrrev_b32 v2, 3, v0
    v_and_b32 v3, 7, v0
    v_bfe_u32 v4, v0, 4, 1
    v_lshlrev_b32 v4, 2, v4
    v_xor_b32 v3, v3, v4
    v_and_b32 v4, 3, v2
    v_lshrrev_b32 v5, 2, v2
    v_lshl_add_u32 v6, v5, 3, v4
    v_mul_u32_u24 v6, 1280, v6
    v_lshl_add_u32 v40, v3, 4, v6
    v_mul_u32_u24 v6, 20, v5
    v_add_u32 v6, v6, v4
    v_mul_u32_u24 v6, 1280, v6
    v_lshl_add_u32 v41, v3, 4, v6
    s_min_u32 s51, s42, 6
L_wil_55:
    s_mul_i32 s53, s51, 51200
    s_mul_i32 s63, s51, 5120
    s_add_u32 m0, s63, 81920
    s_add_u32 s52, s53, 0
    buffer_load_dwordx4 v40, s[28:31], s52 offen lds
    s_add_u32 m0, m0, s62
    s_add_u32 s52, s53, 5120
    buffer_load_dwordx4 v40, s[28:31], s52 offen lds
    s_add_u32 m0, m0, s62
    s_add_u32 s52, s53, 25600
    buffer_load_dwordx4 v40, s[28:31], s52 offen lds
    s_add_u32 m0, m0, s62
    s_add_u32 s52, s53, 30720
    buffer_load_dwordx4 v40, s[28:31], s52 offen lds
    s_add_u32 m0, m0, s62
    s_add_u32 s52, s53, 20480
    buffer_load_dwordx4 v41, s[28:31], s52 offen lds
    s_add_u32 s51, s51, 7
    s_cmp_lt_u32 s51, 16
    s_cbranch_scc1 L_wil_55
L_wi_54:
L_go_51:
    s_waitcnt lgkmcnt(0)
    s_barrier
    v_mov_b32 v3, 71680
    ds_read_b32 v2, v3
    buffer_load_dwordx4 v[8:11], v75, s[32:35], 0 offen sc1
    buffer_load_dwordx4 v[12:15], v76, s[32:35], 0 offen sc1
    v_lshlrev_b32 v4, 4, v0
    s_mov_b32 m0, s74
    s_nop 0
    buffer_load_dwordx4 v4, s[32:35], s66 offen sc1 lds
    s_mov_b32 m0, s75
    s_nop 0
    buffer_load_dwordx4 v4, s[32:35], s67 offen sc1 lds
    s_mov_b32 m0, s76
    s_nop 0
    buffer_load_dwordx4 v4, s[32:35], s68 offen sc1 lds
    s_mov_b32 m0, s77
    s_nop 0
    buffer_load_dwordx4 v4, s[32:35], s69 offen sc1 lds
    s_mov_b32 m0, s78
    s_nop 0
    buffer_load_dwordx4 v4, s[32:35], s70 offen sc1 lds
    s_mov_b32 m0, s79
    s_nop 0
    buffer_load_dwordx4 v4, s[32:35], s71 offen sc1 lds
    s_mov_b32 m0, s80
    s_nop 0
    buffer_load_dwordx4 v4, s[32:35], s72 offen sc1 lds
    s_cmp_ge_u32 s42, 4
    s_cbranch_scc1 L_kv_63
    s_mov_b32 m0, s81
    s_nop 0
    buffer_load_dwordx4 v4, s[32:35], s73 offen sc1 lds
L_kv_63:
    s_mov_b32 s66, 0xffffffff
    s_mov_b32 s67, 0xfffffff0
    s_mov_b32 s68, 0xfffffffe
    s_mov_b32 s69, 0xffffffe0
    s_mov_b32 s70, 0xfffffffc
    s_mov_b32 s71, 0xffffffc0
    s_mov_b32 s72, 0xfffffff8
    s_mov_b32 s73, 0xffffff80
    s_mov_b32 s74, 0xffffff00
    s_mov_b32 s75, 0xfffff000
    s_mov_b32 s76, 0xfffffe00
    s_mov_b32 s77, 0xffffe000
    s_mov_b32 s78, 0xfffffc00
    s_mov_b32 s79, 0xffffc000
    s_mov_b32 s80, 0xfffff800
    s_mov_b32 s81, 0xffff8000
    s_mov_b32 s82, 0xffff0000
    s_mov_b32 s83, 0xfff00000
    s_mov_b32 s84, 0xfffe0000
    s_mov_b32 s85, 0xffe00000
    s_mov_b32 s86, 0xfffc0000
    s_mov_b32 s87, 0xffc00000
    s_mov_b32 s88, 0xfff80000
    s_mov_b32 s89, 0xff800000
    s_mov_b32 s90, 0xff000000
    s_mov_b32 s91, 0xf0000000
    s_mov_b32 s92, 0xfe000000
    s_mov_b32 s93, 0xe0000000
    s_mov_b32 s94, 0xfc000000
    s_mov_b32 s95, 0xc0000000
    s_mov_b32 s96, 0xf8000000
    s_mov_b32 s97, 0x80000000
    v_mov_b32 v6, 0xffff
    v_mov_b32 v7, 0xffff0000
    v_cndmask_b32 v79, 0, v6, s[66:67]
    v_cndmask_b32 v80, 0, v7, s[68:69]
    v_or_b32 v64, v79, v80
    v_cndmask_b32 v79, 0, v6, s[70:71]
    v_cndmask_b32 v80, 0, v7, s[72:73]
    v_or_b32 v65, v79, v80
    v_cndmask_b32 v79, 0, v6, s[74:75]
    v_cndmask_b32 v80, 0, v7, s[76:77]
    v_or_b32 v66, v79, v80
    v_cndmask_b32 v79, 0, v6, s[78:79]
    v_cndmask_b32 v80, 0, v7, s[80:81]
    v_or_b32 v67, v79, v80
    v_cndmask_b32 v79, 0, v6, s[82:83]
    v_cndmask_b32 v80, 0, v7, s[84:85]
    v_or_b32 v68, v79, v80
    v_cndmask_b32 v79, 0, v6, s[86:87]
    v_cndmask_b32 v80, 0, v7, s[88:89]
    v_or_b32 v69, v79, v80
    v_cndmask_b32 v79, 0, v6, s[90:91]
    v_cndmask_b32 v80, 0, v7, s[92:93]
    v_or_b32 v70, v79, v80
    v_cndmask_b32 v79, 0, v6, s[94:95]
    v_cndmask_b32 v80, 0, v7, s[96:97]
    v_or_b32 v71, v79, v80
    s_waitcnt lgkmcnt(0)
    v_readfirstlane_b32 s56, v2
    s_waitcnt vmcnt(0)
    s_barrier
    s_cmp_lg_u32 s42, 6
    s_cbranch_scc1 L_kfs_64
    s_lshl_b32 s52, s40, 5
    s_add_u32 s52, s52, s41
    s_and_b32 s53, s52, 3
    s_lshl_b32 s53, s53, 3
    s_and_b32 s52, s52, 0xfc
    s_lshl_b32 s63, 0x40, s53
    s_atomic_or s63, s[18:19], s52
L_kfs_64:
    s_cmp_ge_u32 s42, 4
    s_cbranch_scc1 L_pf_65
    s_and_b32 s52, s41, 7
    s_cmp_lt_u32 s52, 6
    s_cbranch_scc1 L_pf_66
    s_cmp_lg_u32 s42, 3
    s_cbranch_scc1 L_pf_66
    s_lshr_b32 s53, s41, 3
    s_lshl_b32 s53, s53, 6
    s_lshl_b32 s54, s40, 8
    s_add_u32 s53, s53, s54
    s_lshl_b32 s53, s53, 4
    s_add_u32 s63, s53, 8912896
    s_cmp_eq_u32 s52, 7
    s_cbranch_scc1 L_pf_67
    v_add_u32 v2, 0, v0
    v_lshrrev_b32 v3, 3, v2
    v_and_b32 v4, 7, v2
    v_lshlrev_b32 v3, 15, v3
    v_lshl_add_u32 v3, v4, 7, v3
    buffer_load_dword v250, v3, s[32:35], s63 offen
    s_branch L_pf_66
L_pf_67:
    s_add_u32 s63, s63, 262144
    v_add_u32 v2, 0, v0
    v_lshrrev_b32 v3, 3, v2
    v_and_b32 v4, 7, v2
    v_lshlrev_b32 v3, 15, v3
    v_lshl_add_u32 v3, v4, 7, v3
    buffer_load_dword v250, v3, s[32:35], s63 offen
    v_add_u32 v2, 64, v0
    v_lshrrev_b32 v3, 3, v2
    v_and_b32 v4, 7, v2
    v_lshlrev_b32 v3, 15, v3
    v_lshl_add_u32 v3, v4, 7, v3
    buffer_load_dword v251, v3, s[32:35], s63 offen
    v_add_u32 v2, 128, v0
    v_lshrrev_b32 v3, 3, v2
    v_and_b32 v4, 7, v2
    v_lshlrev_b32 v3, 15, v3
    v_lshl_add_u32 v3, v4, 7, v3
    buffer_load_dword v252, v3, s[32:35], s63 offen
L_pf_66:
L_pf_65:
    s_cmp_lg_u32 s42, 0
    s_cbranch_scc1 L_pf_68
    s_mov_b32 s36, s12
    s_mov_b32 s37, s13
    s_mov_b32 s38, 1966080
    s_mov_b32 s39, 0x20000
    s_mul_i32 s52, s2, 7680
    v_lshlrev_b32 v2, 7, v0
    buffer_load_dword v253, v2, s[36:39], s52 offen
L_pf_68:
    s_cmp_lg_u32 s42, 1
    s_cbranch_scc1 L_pf_69
    s_mov_b32 s36, s14
    s_mov_b32 s37, s15
    s_mov_b32 s38, 1966080
    s_mov_b32 s39, 0x20000
    s_mul_i32 s52, s2, 7680
    v_lshlrev_b32 v2, 7, v0
    buffer_load_dword v253, v2, s[36:39], s52 offen
L_pf_69:
    s_mov_b32 s60, -1
    s_mov_b32 s61, 0
    s_cmp_eq_u32 s48, 0
    s_cbranch_scc1 L_qa_70
    v_mov_b32 v12, 0
    v_mov_b32 v13, 0
    v_cndmask_b32 v14, 0, v14, s[60:61]
    v_cndmask_b32 v15, 0, v15, s[60:61]
    s_branch L_qb_71
L_qa_70:
    v_cndmask_b32 v12, 0, v12, s[60:61]
    v_cndmask_b32 v13, 0, v13, s[60:61]
    v_mov_b32 v14, 0
    v_mov_b32 v15, 0
L_qb_71:
    ds_read_b128 v[16:19], v72 offset:0
    ds_read_b128 v[20:23], v73 offset:0
    ds_read_b128 v[24:27], v72 offset:4096
    ds_read_b128 v[28:31], v73 offset:4096
    ds_read_b128 v[32:35], v72 offset:512
    ds_read_b128 v[36:39], v73 offset:512
    v_mov_b64 v[48:49], 0
    v_mov_b64 v[50:51], 0
    v_mov_b64 v[52:53], 0
    v_mov_b64 v[54:55], 0
    v_mov_b64 v[56:57], 0
    v_mov_b64 v[58:59], 0
    v_mov_b64 v[60:61], 0
    v_mov_b64 v[62:63], 0
    s_waitcnt lgkmcnt(4)
    v_mfma_f32_32x32x16_bf16 v[96:111], v[16:19], v[8:11], 0
    v_mfma_f32_32x32x16_bf16 v[96:111], v[20:23], v[12:15], v[96:111]
    ds_read_b64_tr_b16 v[40:41], v74 offset:0
    ds_read_b64_tr_b16 v[42:43], v74 offset:128
    ds_read_b64_tr_b16 v[44:45], v74 offset:256
    ds_read_b64_tr_b16 v[46:47], v74 offset:384
    s_waitcnt lgkmcnt(6)
    v_mfma_f32_32x32x16_bf16 v[224:239], v[24:27], v[8:11], 0
    v_mfma_f32_32x32x16_bf16 v[224:239], v[28:31], v[12:15], v[224:239]
    ds_read_b128 v[16:19], v72 offset:1024
    ds_read_b128 v[20:23], v73 offset:1024
    s_waitcnt lgkmcnt(6)
    v_mfma_f32_32x32x16_bf16 v[112:127], v[32:35], v[8:11], 0
    v_mfma_f32_32x32x16_bf16 v[112:127], v[36:39], v[12:15], v[112:127]
    ds_read_b64_tr_b16 v[144:145], v74 offset:4096
    ds_read_b64_tr_b16 v[146:147], v74 offset:4224
    ds_read_b64_tr_b16 v[148:149], v74 offset:4352
    ds_read_b64_tr_b16 v[150:151], v74 offset:4480
    s_nop 2
    v_cndmask_b32 v96, v96, v224, s[66:67]
    v_cndmask_b32 v97, v97, v225, s[68:69]
    v_cndmask_b32 v98, v98, v226, s[70:71]
    v_cndmask_b32 v99, v99, v227, s[72:73]
    v_cndmask_b32 v100, v100, v228, s[74:75]
    v_cndmask_b32 v101, v101, v229, s[76:77]
    v_cndmask_b32 v102, v102, v230, s[78:79]
    v_cndmask_b32 v103, v103, v231, s[80:81]
    v_cndmask_b32 v104, v104, v232, s[82:83]
    v_cndmask_b32 v105, v105, v233, s[84:85]
    v_cndmask_b32 v106, v106, v234, s[86:87]
    v_cndmask_b32 v107, v107, v235, s[88:89]
    v_cndmask_b32 v108, v108, v236, s[90:91]
    v_cndmask_b32 v109, v109, v237, s[92:93]
    v_cndmask_b32 v110, v110, v238, s[94:95]
    v_cndmask_b32 v111, v111, v239, s[96:97]
    s_waitcnt lgkmcnt(4)
    v_exp_f32 v96, v96
    v_exp_f32 v97, v97
    v_exp_f32 v98, v98
    v_exp_f32 v99, v99
    v_mfma_f32_32x32x16_bf16 v[128:143], v[16:19], v[8:11], 0
    v_exp_f32 v100, v100
    v_exp_f32 v101, v101
    v_exp_f32 v102, v102
    v_exp_f32 v103, v103
    v_exp_f32 v104, v104
    v_exp_f32 v105, v105
    v_exp_f32 v106, v106
    v_exp_f32 v107, v107
    v_exp_f32 v108, v108
    v_exp_f32 v109, v109
    v_exp_f32 v110, v110
    v_exp_f32 v111, v111
    v_mfma_f32_32x32x16_bf16 v[128:143], v[20:23], v[12:15], v[128:143]
    ds_read_b128 v[24:27], v72 offset:1536
    ds_read_b128 v[28:31], v73 offset:1536
    v_cvt_pk_bf16_f32 v96, v96, v97
    v_cvt_pk_bf16_f32 v97, v98, v99
    v_cvt_pk_bf16_f32 v98, v100, v101
    v_cvt_pk_bf16_f32 v99, v102, v103
    v_cvt_pk_bf16_f32 v104, v104, v105
    v_cvt_pk_bf16_f32 v105, v106, v107
    v_cvt_pk_bf16_f32 v106, v108, v109
    v_cvt_pk_bf16_f32 v107, v110, v111
    v_and_b32 v224, v64, v96
    v_bfi_b32 v96, v64, 0, v96
    v_and_b32 v225, v65, v97
    v_bfi_b32 v97, v65, 0, v97
    v_and_b32 v226, v66, v98
    v_bfi_b32 v98, v66, 0, v98
    v_and_b32 v227, v67, v99
    v_bfi_b32 v99, v67, 0, v99
    v_and_b32 v228, v68, v104
    v_bfi_b32 v104, v68, 0, v104
    v_and_b32 v229, v69, v105
    v_bfi_b32 v105, v69, 0, v105
    v_and_b32 v230, v70, v106
    v_bfi_b32 v106, v70, 0, v106
    v_and_b32 v231, v71, v107
    v_bfi_b32 v107, v71, 0, v107
    s_waitcnt lgkmcnt(8)
    v_mfma_f32_32x32x16_bf16 v[48:63], v[40:43], v[96:99], v[48:63]
    v_exp_f32 v112, v112
    v_exp_f32 v113, v113
    v_exp_f32 v114, v114
    v_mfma_f32_32x32x16_bf16 v[48:63], v[44:47], v[104:107], v[48:63]
    ds_read_b64_tr_b16 v[40:41], v74 offset:512
    ds_read_b64_tr_b16 v[42:43], v74 offset:640
    ds_read_b64_tr_b16 v[44:45], v74 offset:768
    ds_read_b64_tr_b16 v[46:47], v74 offset:896
    v_exp_f32 v115, v115
    v_exp_f32 v116, v116
    v_exp_f32 v117, v117
    s_waitcnt lgkmcnt(6)
    v_mfma_f32_32x32x16_bf16 v[48:63], v[144:147], v[224:227], v[48:63]
    v_exp_f32 v118, v118
    v_exp_f32 v119, v119
    v_cvt_pk_bf16_f32 v112, v112, v113
    v_cvt_pk_bf16_f32 v113, v114, v115
    v_cvt_pk_bf16_f32 v114, v116, v117
    v_cvt_pk_bf16_f32 v115, v118, v119
    v_mfma_f32_32x32x16_bf16 v[48:63], v[148:151], v[228:231], v[48:63]
    ds_read_b64_tr_b16 v[144:145], v74 offset:1024
    ds_read_b64_tr_b16 v[146:147], v74 offset:1152
    ds_read_b64_tr_b16 v[148:149], v74 offset:1280
    ds_read_b64_tr_b16 v[150:151], v74 offset:1408
    v_exp_f32 v120, v120
    v_exp_f32 v121, v121
    s_waitcnt lgkmcnt(6)
    v_mfma_f32_32x32x16_bf16 v[48:63], v[40:43], v[112:115], v[48:63]
    v_exp_f32 v122, v122
    v_exp_f32 v123, v123
    v_exp_f32 v124, v124
    v_exp_f32 v125, v125
    v_exp_f32 v126, v126
    v_exp_f32 v127, v127
    v_cvt_pk_bf16_f32 v120, v120, v121
    v_cvt_pk_bf16_f32 v121, v122, v123
    v_cvt_pk_bf16_f32 v122, v124, v125
    v_cvt_pk_bf16_f32 v123, v126, v127
    s_nop 0
    s_waitcnt lgkmcnt(4)
    v_mfma_f32_32x32x16_bf16 v[48:63], v[44:47], v[120:123], v[48:63]
    ds_read_b64_tr_b16 v[40:41], v74 offset:1536
    ds_read_b64_tr_b16 v[42:43], v74 offset:1664
    ds_read_b64_tr_b16 v[44:45], v74 offset:1792
    ds_read_b64_tr_b16 v[46:47], v74 offset:1920
    v_exp_f32 v128, v128
    v_exp_f32 v129, v129
    v_exp_f32 v130, v130
    v_exp_f32 v131, v131
    s_waitcnt lgkmcnt(12)
    v_mfma_f32_32x32x16_bf16 v[112:127], v[24:27], v[8:11], 0
    v_exp_f32 v132, v132
    v_exp_f32 v133, v133
    v_exp_f32 v134, v134
    v_exp_f32 v135, v135
    v_cvt_pk_bf16_f32 v128, v128, v129
    v_cvt_pk_bf16_f32 v129, v130, v131
    v_cvt_pk_bf16_f32 v130, v132, v133
    v_cvt_pk_bf16_f32 v131, v134, v135
    v_exp_f32 v136, v136
    v_exp_f32 v137, v137
    s_waitcnt lgkmcnt(6)
    v_mfma_f32_32x32x16_bf16 v[48:63], v[144:147], v[128:131], v[48:63]
    v_exp_f32 v138, v138
    v_exp_f32 v139, v139
    v_exp_f32 v140, v140
    v_mfma_f32_32x32x16_bf16 v[112:127], v[28:31], v[12:15], v[112:127]
    v_exp_f32 v141, v141
    v_exp_f32 v142, v142
    v_exp_f32 v143, v143
    v_cvt_pk_bf16_f32 v136, v136, v137
    v_cvt_pk_bf16_f32 v137, v138, v139
    v_cvt_pk_bf16_f32 v138, v140, v141
    v_cvt_pk_bf16_f32 v139, v142, v143
    ds_read_b128 v[32:35], v72 offset:2048
    ds_read_b128 v[36:39], v73 offset:2048
    s_nop 0
    s_waitcnt lgkmcnt(6)
    v_mfma_f32_32x32x16_bf16 v[48:63], v[148:151], v[136:139], v[48:63]
    ds_read_b64_tr_b16 v[144:145], v74 offset:2048
    ds_read_b64_tr_b16 v[146:147], v74 offset:2176
    ds_read_b64_tr_b16 v[148:149], v74 offset:2304
    ds_read_b64_tr_b16 v[150:151], v74 offset:2432
    v_exp_f32 v112, v112
    v_exp_f32 v113, v113
    v_exp_f32 v114, v114
    v_exp_f32 v115, v115
    s_waitcnt lgkmcnt(4)
    v_mfma_f32_32x32x16_bf16 v[128:143], v[32:35], v[8:11], 0
    v_exp_f32 v116, v116
    v_exp_f32 v117, v117
    v_exp_f32 v118, v118
    v_exp_f32 v119, v119
    v_cvt_pk_bf16_f32 v112, v112, v113
    v_cvt_pk_bf16_f32 v113, v114, v115
    v_cvt_pk_bf16_f32 v114, v116, v117
    v_cvt_pk_bf16_f32 v115, v118, v119
    v_exp_f32 v120, v120
    v_exp_f32 v121, v121
    s_waitcnt lgkmcnt(8)
    v_mfma_f32_32x32x16_bf16 v[48:63], v[40:43], v[112:115], v[48:63]
    v_exp_f32 v122, v122
    v_exp_f32 v123, v123
    v_exp_f32 v124, v124
    v_mfma_f32_32x32x16_bf16 v[128:143], v[36:39], v[12:15], v[128:143]
    v_exp_f32 v125, v125
    v_exp_f32 v126, v126
    v_exp_f32 v127, v127
    v_cvt_pk_bf16_f32 v120, v120, v121
    v_cvt_pk_bf16_f32 v121, v122, v123
    v_cvt_pk_bf16_f32 v122, v124, v125
    v_cvt_pk_bf16_f32 v123, v126, v127
    ds_read_b128 v[16:19], v72 offset:2560
    ds_read_b128 v[20:23], v73 offset:2560
    s_nop 0
    s_waitcnt lgkmcnt(8)
    v_mfma_f32_32x32x16_bf16 v[48:63], v[44:47], v[120:123], v[48:63]
    ds_read_b64_tr_b16 v[40:41], v74 offset:2560
    ds_read_b64_tr_b16 v[42:43], v74 offset:2688
    ds_read_b64_tr_b16 v[44:45], v74 offset:2816
    ds_read_b64_tr_b16 v[46:47], v74 offset:2944
    v_exp_f32 v128, v128
    v_exp_f32 v129, v129
    v_exp_f32 v130, v130
    v_exp_f32 v131, v131
    s_waitcnt lgkmcnt(4)
    v_mfma_f32_32x32x16_bf16 v[112:127], v[16:19], v[8:11], 0
    v_exp_f32 v132, v132
    v_exp_f32 v133, v133
    v_exp_f32 v134, v134
    v_exp_f32 v135, v135
    v_cvt_pk_bf16_f32 v128, v128, v129
    v_cvt_pk_bf16_f32 v129, v130, v131
    v_cvt_pk_bf16_f32 v130, v132, v133
    v_cvt_pk_bf16_f32 v131, v134, v135
    v_exp_f32 v136, v136
    v_exp_f32 v137, v137
    s_waitcnt lgkmcnt(8)
    v_mfma_f32_32x32x16_bf16 v[48:63], v[144:147], v[128:131], v[48:63]
    v_exp_f32 v138, v138
    v_exp_f32 v139, v139
    v_exp_f32 v140, v140
    v_mfma_f32_32x32x16_bf16 v[112:127], v[20:23], v[12:15], v[112:127]
    v_exp_f32 v141, v141
    v_exp_f32 v142, v142
    v_exp_f32 v143, v143
    v_cvt_pk_bf16_f32 v136, v136, v137
    v_cvt_pk_bf16_f32 v137, v138, v139
    v_cvt_pk_bf16_f32 v138, v140, v141
    v_cvt_pk_bf16_f32 v139, v142, v143
    ds_read_b128 v[24:27], v72 offset:3072
    ds_read_b128 v[28:31], v73 offset:3072
    s_nop 0
    s_waitcnt lgkmcnt(8)
    v_mfma_f32_32x32x16_bf16 v[48:63], v[148:151], v[136:139], v[48:63]
    ds_read_b64_tr_b16 v[144:145], v74 offset:3072
    ds_read_b64_tr_b16 v[146:147], v74 offset:3200
    ds_read_b64_tr_b16 v[148:149], v74 offset:3328
    ds_read_b64_tr_b16 v[150:151], v74 offset:3456
    v_exp_f32 v112, v112
    v_exp_f32 v113, v113
    v_exp_f32 v114, v114
    v_exp_f32 v115, v115
    s_waitcnt lgkmcnt(4)
    v_mfma_f32_32x32x16_bf16 v[128:143], v[24:27], v[8:11], 0
    v_exp_f32 v116, v116
    v_exp_f32 v117, v117
    v_exp_f32 v118, v118
    v_exp_f32 v119, v119
    v_cvt_pk_bf16_f32 v112, v112, v113
    v_cvt_pk_bf16_f32 v113, v114, v115
    v_cvt_pk_bf16_f32 v114, v116, v117
    v_cvt_pk_bf16_f32 v115, v118, v119
    v_exp_f32 v120, v120
    v_exp_f32 v121, v121
    s_waitcnt lgkmcnt(8)
    v_mfma_f32_32x32x16_bf16 v[48:63], v[40:43], v[112:115], v[48:63]
    v_exp_f32 v122, v122
    v_exp_f32 v123, v123
    v_exp_f32 v124, v124
    v_mfma_f32_32x32x16_bf16 v[128:143], v[28:31], v[12:15], v[128:143]
    v_exp_f32 v125, v125
    v_exp_f32 v126, v126
    v_exp_f32 v127, v127
    v_cvt_pk_bf16_f32 v120, v120, v121
    v_cvt_pk_bf16_f32 v121, v122, v123
    v_cvt_pk_bf16_f32 v122, v124, v125
    v_cvt_pk_bf16_f32 v123, v126, v127
    ds_read_b128 v[32:35], v72 offset:3584
    ds_read_b128 v[36:39], v73 offset:3584
    s_nop 0
    s_waitcnt lgkmcnt(8)
    v_mfma_f32_32x32x16_bf16 v[48:63], v[44:47], v[120:123], v[48:63]
    ds_read_b64_tr_b16 v[40:41], v74 offset:3584
    ds_read_b64_tr_b16 v[42:43], v74 offset:3712
    ds_read_b64_tr_b16 v[44:45], v74 offset:3840
    ds_read_b64_tr_b16 v[46:47], v74 offset:3968
    v_exp_f32 v128, v128
    v_exp_f32 v129, v129
    v_exp_f32 v130, v130
    v_exp_f32 v131, v131
    s_waitcnt lgkmcnt(4)
    v_mfma_f32_32x32x16_bf16 v[112:127], v[32:35], v[8:11], 0
    v_exp_f32 v132, v132
    v_exp_f32 v133, v133
    v_exp_f32 v134, v134
    v_exp_f32 v135, v135
    v_cvt_pk_bf16_f32 v128, v128, v129
    v_cvt_pk_bf16_f32 v129, v130, v131
    v_cvt_pk_bf16_f32 v130, v132, v133
    v_cvt_pk_bf16_f32 v131, v134, v135
    v_exp_f32 v136, v136
    v_exp_f32 v137, v137
    s_waitcnt lgkmcnt(8)
    v_mfma_f32_32x32x16_bf16 v[48:63], v[144:147], v[128:131], v[48:63]
    v_exp_f32 v138, v138
    v_exp_f32 v139, v139
    v_exp_f32 v140, v140
    v_mfma_f32_32x32x16_bf16 v[112:127], v[36:39], v[12:15], v[112:127]
    v_exp_f32 v141, v141
    v_exp_f32 v142, v142
    v_exp_f32 v143, v143
    v_cvt_pk_bf16_f32 v136, v136, v137
    v_cvt_pk_bf16_f32 v137, v138, v139
    v_cvt_pk_bf16_f32 v138, v140, v141
    v_cvt_pk_bf16_f32 v139, v142, v143
    s_nop 0
    s_waitcnt lgkmcnt(6)
    v_mfma_f32_32x32x16_bf16 v[48:63], v[148:151], v[136:139], v[48:63]
    s_nop 1
    v_exp_f32 v112, v112
    v_exp_f32 v113, v113
    v_exp_f32 v114, v114
    v_exp_f32 v115, v115
    v_exp_f32 v116, v116
    v_exp_f32 v117, v117
    v_exp_f32 v118, v118
    v_exp_f32 v119, v119
    v_cvt_pk_bf16_f32 v112, v112, v113
    v_cvt_pk_bf16_f32 v113, v114, v115
    v_cvt_pk_bf16_f32 v114, v116, v117
    v_cvt_pk_bf16_f32 v115, v118, v119
    v_exp_f32 v120, v120
    v_exp_f32 v121, v121
    s_waitcnt lgkmcnt(2)
    v_mfma_f32_32x32x16_bf16 v[48:63], v[40:43], v[112:115], v[48:63]
    v_exp_f32 v122, v122
    v_exp_f32 v123, v123
    v_exp_f32 v124, v124
    v_exp_f32 v125, v125
    v_exp_f32 v126, v126
    v_exp_f32 v127, v127
    v_cvt_pk_bf16_f32 v120, v120, v121
    v_cvt_pk_bf16_f32 v121, v122, v123
    v_cvt_pk_bf16_f32 v122, v124, v125
    v_cvt_pk_bf16_f32 v123, v126, v127
    s_nop 0
    s_waitcnt lgkmcnt(0)
    v_mfma_f32_32x32x16_bf16 v[48:63], v[44:47], v[120:123], v[48:63]
    s_nop 11
    v_mov_b32 v80, v56
    v_mov_b32 v81, v56
    s_nop 1
    v_permlane32_swap_b32 v80, v81
    v_mov_b32 v82, 0x1f800000
    v_mov_b32 v83, 0x5f800000
    v_cmp_ge_f32 s[60:61], v81, v82
    v_cmp_le_f32 vcc, v81, v83
    s_nop 2
    s_and_b64 vcc, vcc, s[60:61]
    s_cmp_eq_u64 vcc, -1
    s_cbranch_scc0 L_slow_72
L_norm_73:
    s_nop 10
    v_mov_b32 v80, v56
    v_mov_b32 v81, v56
    s_nop 1
    v_permlane32_swap_b32 v80, v81
    v_rcp_f32 v81, v81
    s_nop 0
    v_mul_f32 v48, v81, v48
    v_mul_f32 v49, v81, v49
    v_mul_f32 v50, v81, v50
    v_mul_f32 v51, v81, v51
    v_mul_f32 v52, v81, v52
    v_mul_f32 v53, v81, v53
    v_mul_f32 v54, v81, v54
    v_mul_f32 v55, v81, v55
    v_mul_f32 v56, v81, v56
    v_mul_f32 v57, v81, v57
    v_mul_f32 v58, v81, v58
    v_mul_f32 v59, v81, v59
    v_cvt_pk_bf16_f32 v84, v48, v49
    v_cvt_pk_bf16_f32 v85, v50, v51
    v_cvt_pk_bf16_f32 v86, v52, v53
    v_cvt_pk_bf16_f32 v87, v54, v55
    v_cvt_pk_bf16_f32 v88, v56, v57
    v_cvt_pk_bf16_f32 v89, v58, v59
    s_cmp_eq_u32 s56, 1
    s_cbranch_scc1 L_sm_74
    buffer_store_dwordx4 v[84:87], v77, s[32:35], 0 offen sc1
    s_mov_b32 exec_hi, 0
    buffer_store_dwordx2 v[88:89], v78, s[32:35], 0 offen sc1
    s_mov_b32 exec_hi, -1
    s_branch L_sm_75
L_sm_74:
    buffer_store_dwordx4 v[84:87], v77, s[32:35], 0 offen
    s_mov_b32 exec_hi, 0
    buffer_store_dwordx2 v[88:89], v78, s[32:35], 0 offen
    s_mov_b32 exec_hi, -1
L_sm_75:
    s_waitcnt vmcnt(0)
    s_barrier
    s_cmp_lg_u32 s42, 6
    s_cbranch_scc1 L_w_76
    s_lshl_b32 s52, s40, 8
    s_lshl_b32 s53, s41, 2
    s_add_u32 s52, s52, s53
    s_add_u32 s52, s52, 32768
    v_mov_b32 v2, 3
    v_mov_b32 v3, 0
    s_mov_b64 exec, 1
    s_cmp_eq_u32 s56, 1
    s_cbranch_scc1 L_sm_77
    buffer_store_dword v2, v3, s[32:35], s52 offen sc1
    s_branch L_sm_78
L_sm_77:
    buffer_store_dword v2, v3, s[32:35], s52 offen
L_sm_78:
    s_mov_b64 exec, -1
L_w_76:
    s_branch L_P3
L_slow_72:
    s_nop 7
    ds_read_b128 v[16:19], v72 offset:0
    ds_read_b128 v[20:23], v73 offset:0
    ds_read_b128 v[24:27], v72 offset:512
    ds_read_b128 v[28:31], v73 offset:512
    s_waitcnt lgkmcnt(2)
    v_mfma_f32_32x32x16_bf16 v[96:111], v[16:19], v[8:11], 0
    v_mfma_f32_32x32x16_bf16 v[96:111], v[20:23], v[12:15], v[96:111]
    ds_read_b128 v[16:19], v72 offset:1024
    ds_read_b128 v[20:23], v73 offset:1024
    s_waitcnt lgkmcnt(2)
    v_mfma_f32_32x32x16_bf16 v[112:127], v[24:27], v[8:11], 0
    v_mfma_f32_32x32x16_bf16 v[112:127], v[28:31], v[12:15], v[112:127]
    ds_read_b128 v[24:27], v72 offset:1536
    ds_read_b128 v[28:31], v73 offset:1536
    s_waitcnt lgkmcnt(2)
    v_mfma_f32_32x32x16_bf16 v[128:143], v[16:19], v[8:11], 0
    v_mfma_f32_32x32x16_bf16 v[128:143], v[20:23], v[12:15], v[128:143]
    ds_read_b128 v[16:19], v72 offset:2048
    ds_read_b128 v[20:23], v73 offset:2048
    s_waitcnt lgkmcnt(2)
    v_mfma_f32_32x32x16_bf16 v[144:159], v[24:27], v[8:11], 0
    v_mfma_f32_32x32x16_bf16 v[144:159], v[28:31], v[12:15], v[144:159]
    ds_read_b128 v[24:27], v72 offset:2560
    ds_read_b128 v[28:31], v73 offset:2560
    s_waitcnt lgkmcnt(2)
    v_mfma_f32_32x32x16_bf16 v[160:175], v[16:19], v[8:11], 0
    v_mfma_f32_32x32x16_bf16 v[160:175], v[20:23], v[12:15], v[160:175]
    ds_read_b128 v[16:19], v72 offset:3072
    ds_read_b128 v[20:23], v73 offset:3072
    s_waitcnt lgkmcnt(2)
    v_mfma_f32_32x32x16_bf16 v[176:191], v[24:27], v[8:11], 0
    v_mfma_f32_32x32x16_bf16 v[176:191], v[28:31], v[12:15], v[176:191]
    ds_read_b128 v[24:27], v72 offset:3584
    ds_read_b128 v[28:31], v73 offset:3584
    s_waitcnt lgkmcnt(2)
    v_mfma_f32_32x32x16_bf16 v[192:207], v[16:19], v[8:11], 0
    v_mfma_f32_32x32x16_bf16 v[192:207], v[20:23], v[12:15], v[192:207]
    ds_read_b128 v[16:19], v72 offset:4096
    ds_read_b128 v[20:23], v73 offset:4096
    s_waitcnt lgkmcnt(2)
    v_mfma_f32_32x32x16_bf16 v[208:223], v[24:27], v[8:11], 0
    v_mfma_f32_32x32x16_bf16 v[208:223], v[28:31], v[12:15], v[208:223]
    s_waitcnt lgkmcnt(0)
    v_mfma_f32_32x32x16_bf16 v[224:239], v[16:19], v[8:11], 0
    v_mfma_f32_32x32x16_bf16 v[224:239], v[20:23], v[12:15], v[224:239]
    ds_read_b64_tr_b16 v[32:33], v74 offset:0
    ds_read_b64_tr_b16 v[34:35], v74 offset:128
    ds_read_b64_tr_b16 v[36:37], v74 offset:256
    ds_read_b64_tr_b16 v[38:39], v74 offset:384
    s_lshr_b32 s52, s43, 5
    s_add_u32 s52, s52, s47
    s_cmp_lt_u32 s52, 8
    s_cbranch_scc1 L_fix_79
L_ret_80:
    s_nop 3
    v_cndmask_b32 v96, v96, v224, s[66:67]
    v_cndmask_b32 v97, v97, v225, s[68:69]
    v_cndmask_b32 v98, v98, v226, s[70:71]
    v_cndmask_b32 v99, v99, v227, s[72:73]
    v_cndmask_b32 v100, v100, v228, s[74:75]
    v_cndmask_b32 v101, v101, v229, s[76:77]
    v_cndmask_b32 v102, v102, v230, s[78:79]
    v_cndmask_b32 v103, v103, v231, s[80:81]
    v_cndmask_b32 v104, v104, v232, s[82:83]
    v_cndmask_b32 v105, v105, v233, s[84:85]
    v_cndmask_b32 v106, v106, v234, s[86:87]
    v_cndmask_b32 v107, v107, v235, s[88:89]
    v_cndmask_b32 v108, v108, v236, s[90:91]
    v_cndmask_b32 v109, v109, v237, s[92:93]
    v_cndmask_b32 v110, v110, v238, s[94:95]
    v_cndmask_b32 v111, v111, v239, s[96:97]
    v_max3_f32 v80, v96, v97, v98
    v_max3_f32 v81, v99, v100, v101
    v_max3_f32 v82, v102, v103, v104
    v_max3_f32 v83, v105, v106, v107
    v_max3_f32 v80, v80, v108, v109
    v_max3_f32 v81, v81, v110, v111
    v_max3_f32 v82, v82, v112, v113
    v_max3_f32 v83, v83, v114, v115
    v_max3_f32 v80, v80, v116, v117
    v_max3_f32 v81, v81, v118, v119
    v_max3_f32 v82, v82, v120, v121
    v_max3_f32 v83, v83, v122, v123
    v_max3_f32 v80, v80, v124, v125
    v_max3_f32 v81, v81, v126, v127
    v_max3_f32 v82, v82, v128, v129
    v_max3_f32 v83, v83, v130, v131
    v_max3_f32 v80, v80, v132, v133
    v_max3_f32 v81, v81, v134, v135
    v_max3_f32 v82, v82, v136, v137
    v_max3_f32 v83, v83, v138, v139
    v_max3_f32 v80, v80, v140, v141
    v_max3_f32 v81, v81, v142, v143
    v_max3_f32 v82, v82, v144, v145
    v_max3_f32 v83, v83, v146, v147
    v_max3_f32 v80, v80, v148, v149
    v_max3_f32 v81, v81, v150, v151
    v_max3_f32 v82, v82, v152, v153
    v_max3_f32 v83, v83, v154, v155
    v_max3_f32 v80, v80, v156, v157
    v_max3_f32 v81, v81, v158, v159
    v_max3_f32 v82, v82, v160, v161
    v_max3_f32 v83, v83, v162, v163
    v_max3_f32 v80, v80, v164, v165
    v_max3_f32 v81, v81, v166, v167
    v_max3_f32 v82, v82, v168, v169
    v_max3_f32 v83, v83, v170, v171
    v_max3_f32 v80, v80, v172, v173
    v_max3_f32 v81, v81, v174, v175
    v_max3_f32 v82, v82, v176, v177
    v_max3_f32 v83, v83, v178, v179
    v_max3_f32 v80, v80, v180, v181
    v_max3_f32 v81, v81, v182, v183
    v_max3_f32 v82, v82, v184, v185
    v_max3_f32 v83, v83, v186, v187
    v_max3_f32 v80, v80, v188, v189
    v_max3_f32 v81, v81, v190, v191
    v_max3_f32 v82, v82, v192, v193
    v_max3_f32 v83, v83, v194, v195
    v_max3_f32 v80, v80, v196, v197
    v_max3_f32 v81, v81, v198, v199
    v_max3_f32 v82, v82, v200, v201
    v_max3_f32 v83, v83, v202, v203
    v_max3_f32 v80, v80, v204, v205
    v_max3_f32 v81, v81, v206, v207
    v_max3_f32 v82, v82, v208, v209
    v_max3_f32 v83, v83, v210, v211
    v_max3_f32 v80, v80, v212, v213
    v_max3_f32 v81, v81, v214, v215
    v_max3_f32 v82, v82, v216, v217
    v_max3_f32 v83, v83, v218, v219
    v_max3_f32 v80, v80, v220, v221
    v_max3_f32 v81, v81, v222, v223
    v_max3_f32 v80, v80, v81, v82
    v_max_f32 v80, v80, v83
    v_mov_b32 v81, v80
    s_nop 1
    v_permlane32_swap_b32 v80, v81
    v_max_f32 v80, v80, v81
    v_sub_f32 v80, 0, v80
    v_mov_b32 v81, v80
    v_mov_b64 v[48:49], 0
    v_mov_b64 v[50:51], 0
    v_mov_b64 v[52:53], 0
    v_mov_b64 v[54:55], 0
    v_mov_b64 v[56:57], 0
    v_mov_b64 v[58:59], 0
    v_mov_b64 v[60:61], 0
    v_mov_b64 v[62:63], 0
    v_pk_add_f32 v[96:97], v[96:97], v[80:81]
    v_pk_add_f32 v[98:99], v[98:99], v[80:81]
    v_pk_add_f32 v[100:101], v[100:101], v[80:81]
    v_pk_add_f32 v[102:103], v[102:103], v[80:81]
    v_pk_add_f32 v[104:105], v[104:105], v[80:81]
    v_pk_add_f32 v[106:107], v[106:107], v[80:81]
    v_pk_add_f32 v[108:109], v[108:109], v[80:81]
    v_pk_add_f32 v[110:111], v[110:111], v[80:81]
    v_exp_f32 v96, v96
    v_exp_f32 v97, v97
    v_exp_f32 v98, v98
    v_exp_f32 v99, v99
    v_exp_f32 v100, v100
    v_exp_f32 v101, v101
    v_exp_f32 v102, v102
    v_exp_f32 v103, v103
    v_exp_f32 v104, v104
    v_exp_f32 v105, v105
    v_exp_f32 v106, v106
    v_exp_f32 v107, v107
    v_exp_f32 v108, v108
    v_exp_f32 v109, v109
    v_exp_f32 v110, v110
    v_exp_f32 v111, v111
    v_cvt_pk_bf16_f32 v96, v96, v97
    v_cvt_pk_bf16_f32 v97, v98, v99
    v_cvt_pk_bf16_f32 v98, v100, v101
    v_cvt_pk_bf16_f32 v99, v102, v103
    v_cvt_pk_bf16_f32 v104, v104, v105
    v_cvt_pk_bf16_f32 v105, v106, v107
    v_cvt_pk_bf16_f32 v106, v108, v109
    v_cvt_pk_bf16_f32 v107, v110, v111
    v_and_b32 v224, v64, v96
    v_bfi_b32 v96, v64, 0, v96
    v_and_b32 v225, v65, v97
    v_bfi_b32 v97, v65, 0, v97
    v_and_b32 v226, v66, v98
    v_bfi_b32 v98, v66, 0, v98
    v_and_b32 v227, v67, v99
    v_bfi_b32 v99, v67, 0, v99
    v_and_b32 v228, v68, v104
    v_bfi_b32 v104, v68, 0, v104
    v_and_b32 v229, v69, v105
    v_bfi_b32 v105, v69, 0, v105
    v_and_b32 v230, v70, v106
    v_bfi_b32 v106, v70, 0, v106
    v_and_b32 v231, v71, v107
    v_bfi_b32 v107, v71, 0, v107
    ds_read_b64_tr_b16 v[40:41], v74 offset:512
    ds_read_b64_tr_b16 v[42:43], v74 offset:640
    ds_read_b64_tr_b16 v[44:45], v74 offset:768
    ds_read_b64_tr_b16 v[46:47], v74 offset:896
    s_waitcnt lgkmcnt(4)
    v_mfma_f32_32x32x16_bf16 v[48:63], v[32:35], v[96:99], v[48:63]
    v_mfma_f32_32x32x16_bf16 v[48:63], v[36:39], v[104:107], v[48:63]
    ds_read_b64_tr_b16 v[32:33], v74 offset:1024
    ds_read_b64_tr_b16 v[34:35], v74 offset:1152
    ds_read_b64_tr_b16 v[36:37], v74 offset:1280
    ds_read_b64_tr_b16 v[38:39], v74 offset:1408
    v_pk_add_f32 v[112:113], v[112:113], v[80:81]
    v_pk_add_f32 v[114:115], v[114:115], v[80:81]
    v_pk_add_f32 v[116:117], v[116:117], v[80:81]
    v_pk_add_f32 v[118:119], v[118:119], v[80:81]
    v_pk_add_f32 v[120:121], v[120:121], v[80:81]
    v_pk_add_f32 v[122:123], v[122:123], v[80:81]
    v_pk_add_f32 v[124:125], v[124:125], v[80:81]
    v_pk_add_f32 v[126:127], v[126:127], v[80:81]
    v_exp_f32 v112, v112
    v_exp_f32 v113, v113
    v_exp_f32 v114, v114
    v_exp_f32 v115, v115
    v_exp_f32 v116, v116
    v_exp_f32 v117, v117
    v_exp_f32 v118, v118
    v_exp_f32 v119, v119
    v_exp_f32 v120, v120
    v_exp_f32 v121, v121
    v_exp_f32 v122, v122
    v_exp_f32 v123, v123
    v_exp_f32 v124, v124
    v_exp_f32 v125, v125
    v_exp_f32 v126, v126
    v_exp_f32 v127, v127
    v_cvt_pk_bf16_f32 v112, v112, v113
    v_cvt_pk_bf16_f32 v113, v114, v115
    v_cvt_pk_bf16_f32 v114, v116, v117
    v_cvt_pk_bf16_f32 v115, v118, v119
    v_cvt_pk_bf16_f32 v120, v120, v121
    v_cvt_pk_bf16_f32 v121, v122, v123
    v_cvt_pk_bf16_f32 v122, v124, v125
    v_cvt_pk_bf16_f32 v123, v126, v127
    s_waitcnt lgkmcnt(4)
    v_mfma_f32_32x32x16_bf16 v[48:63], v[40:43], v[112:115], v[48:63]
    v_mfma_f32_32x32x16_bf16 v[48:63], v[44:47], v[120:123], v[48:63]
    ds_read_b64_tr_b16 v[40:41], v74 offset:1536
    ds_read_b64_tr_b16 v[42:43], v74 offset:1664
    ds_read_b64_tr_b16 v[44:45], v74 offset:1792
    ds_read_b64_tr_b16 v[46:47], v74 offset:1920
    v_pk_add_f32 v[128:129], v[128:129], v[80:81]
    v_pk_add_f32 v[130:131], v[130:131], v[80:81]
    v_pk_add_f32 v[132:133], v[132:133], v[80:81]
    v_pk_add_f32 v[134:135], v[134:135], v[80:81]
    v_pk_add_f32 v[136:137], v[136:137], v[80:81]
    v_pk_add_f32 v[138:139], v[138:139], v[80:81]
    v_pk_add_f32 v[140:141], v[140:141], v[80:81]
    v_pk_add_f32 v[142:143], v[142:143], v[80:81]
    v_exp_f32 v128, v128
    v_exp_f32 v129, v129
    v_exp_f32 v130, v130
    v_exp_f32 v131, v131
    v_exp_f32 v132, v132
    v_exp_f32 v133, v133
    v_exp_f32 v134, v134
    v_exp_f32 v135, v135
    v_exp_f32 v136, v136
    v_exp_f32 v137, v137
    v_exp_f32 v138, v138
    v_exp_f32 v139, v139
    v_exp_f32 v140, v140
    v_exp_f32 v141, v141
    v_exp_f32 v142, v142
    v_exp_f32 v143, v143
    v_cvt_pk_bf16_f32 v128, v128, v129
    v_cvt_pk_bf16_f32 v129, v130, v131
    v_cvt_pk_bf16_f32 v130, v132, v133
    v_cvt_pk_bf16_f32 v131, v134, v135
    v_cvt_pk_bf16_f32 v136, v136, v137
    v_cvt_pk_bf16_f32 v137, v138, v139
    v_cvt_pk_bf16_f32 v138, v140, v141
    v_cvt_pk_bf16_f32 v139, v142, v143
    s_waitcnt lgkmcnt(4)
    v_mfma_f32_32x32x16_bf16 v[48:63], v[32:35], v[128:131], v[48:63]
    v_mfma_f32_32x32x16_bf16 v[48:63], v[36:39], v[136:139], v[48:63]
    ds_read_b64_tr_b16 v[32:33], v74 offset:2048
    ds_read_b64_tr_b16 v[34:35], v74 offset:2176
    ds_read_b64_tr_b16 v[36:37], v74 offset:2304
    ds_read_b64_tr_b16 v[38:39], v74 offset:2432
    v_pk_add_f32 v[144:145], v[144:145], v[80:81]
    v_pk_add_f32 v[146:147], v[146:147], v[80:81]
    v_pk_add_f32 v[148:149], v[148:149], v[80:81]
    v_pk_add_f32 v[150:151], v[150:151], v[80:81]
    v_pk_add_f32 v[152:153], v[152:153], v[80:81]
    v_pk_add_f32 v[154:155], v[154:155], v[80:81]
    v_pk_add_f32 v[156:157], v[156:157], v[80:81]
    v_pk_add_f32 v[158:159], v[158:159], v[80:81]
    v_exp_f32 v144, v144
    v_exp_f32 v145, v145
    v_exp_f32 v146, v146
    v_exp_f32 v147, v147
    v_exp_f32 v148, v148
    v_exp_f32 v149, v149
    v_exp_f32 v150, v150
    v_exp_f32 v151, v151
    v_exp_f32 v152, v152
    v_exp_f32 v153, v153
    v_exp_f32 v154, v154
    v_exp_f32 v155, v155
    v_exp_f32 v156, v156
    v_exp_f32 v157, v157
    v_exp_f32 v158, v158
    v_exp_f32 v159, v159
    v_cvt_pk_bf16_f32 v144, v144, v145
    v_cvt_pk_bf16_f32 v145, v146, v147
    v_cvt_pk_bf16_f32 v146, v148, v149
    v_cvt_pk_bf16_f32 v147, v150, v151
    v_cvt_pk_bf16_f32 v152, v152, v153
    v_cvt_pk_bf16_f32 v153, v154, v155
    v_cvt_pk_bf16_f32 v154, v156, v157
    v_cvt_pk_bf16_f32 v155, v158, v159
    s_waitcnt lgkmcnt(4)
    v_mfma_f32_32x32x16_bf16 v[48:63], v[40:43], v[144:147], v[48:63]
    v_mfma_f32_32x32x16_bf16 v[48:63], v[44:47], v[152:155], v[48:63]
    ds_read_b64_tr_b16 v[40:41], v74 offset:2560
    ds_read_b64_tr_b16 v[42:43], v74 offset:2688
    ds_read_b64_tr_b16 v[44:45], v74 offset:2816
    ds_read_b64_tr_b16 v[46:47], v74 offset:2944
    v_pk_add_f32 v[160:161], v[160:161], v[80:81]
    v_pk_add_f32 v[162:163], v[162:163], v[80:81]
    v_pk_add_f32 v[164:165], v[164:165], v[80:81]
    v_pk_add_f32 v[166:167], v[166:167], v[80:81]
    v_pk_add_f32 v[168:169], v[168:169], v[80:81]
    v_pk_add_f32 v[170:171], v[170:171], v[80:81]
    v_pk_add_f32 v[172:173], v[172:173], v[80:81]
    v_pk_add_f32 v[174:175], v[174:175], v[80:81]
    v_exp_f32 v160, v160
    v_exp_f32 v161, v161
    v_exp_f32 v162, v162
    v_exp_f32 v163, v163
    v_exp_f32 v164, v164
    v_exp_f32 v165, v165
    v_exp_f32 v166, v166
    v_exp_f32 v167, v167
    v_exp_f32 v168, v168
    v_exp_f32 v169, v169
    v_exp_f32 v170, v170
    v_exp_f32 v171, v171
    v_exp_f32 v172, v172
    v_exp_f32 v173, v173
    v_exp_f32 v174, v174
    v_exp_f32 v175, v175
    v_cvt_pk_bf16_f32 v160, v160, v161
    v_cvt_pk_bf16_f32 v161, v162, v163
    v_cvt_pk_bf16_f32 v162, v164, v165
    v_cvt_pk_bf16_f32 v163, v166, v167
    v_cvt_pk_bf16_f32 v168, v168, v169
    v_cvt_pk_bf16_f32 v169, v170, v171
    v_cvt_pk_bf16_f32 v170, v172, v173
    v_cvt_pk_bf16_f32 v171, v174, v175
    s_waitcnt lgkmcnt(4)
    v_mfma_f32_32x32x16_bf16 v[48:63], v[32:35], v[160:163], v[48:63]
    v_mfma_f32_32x32x16_bf16 v[48:63], v[36:39], v[168:171], v[48:63]
    ds_read_b64_tr_b16 v[32:33], v74 offset:3072
    ds_read_b64_tr_b16 v[34:35], v74 offset:3200
    ds_read_b64_tr_b16 v[36:37], v74 offset:3328
    ds_read_b64_tr_b16 v[38:39], v74 offset:3456
    v_pk_add_f32 v[176:177], v[176:177], v[80:81]
    v_pk_add_f32 v[178:179], v[178:179], v[80:81]
    v_pk_add_f32 v[180:181], v[180:181], v[80:81]
    v_pk_add_f32 v[182:183], v[182:183], v[80:81]
    v_pk_add_f32 v[184:185], v[184:185], v[80:81]
    v_pk_add_f32 v[186:187], v[186:187], v[80:81]
    v_pk_add_f32 v[188:189], v[188:189], v[80:81]
    v_pk_add_f32 v[190:191], v[190:191], v[80:81]
    v_exp_f32 v176, v176
    v_exp_f32 v177, v177
    v_exp_f32 v178, v178
    v_exp_f32 v179, v179
    v_exp_f32 v180, v180
    v_exp_f32 v181, v181
    v_exp_f32 v182, v182
    v_exp_f32 v183, v183
    v_exp_f32 v184, v184
    v_exp_f32 v185, v185
    v_exp_f32 v186, v186
    v_exp_f32 v187, v187
    v_exp_f32 v188, v188
    v_exp_f32 v189, v189
    v_exp_f32 v190, v190
    v_exp_f32 v191, v191
    v_cvt_pk_bf16_f32 v176, v176, v177
    v_cvt_pk_bf16_f32 v177, v178, v179
    v_cvt_pk_bf16_f32 v178, v180, v181
    v_cvt_pk_bf16_f32 v179, v182, v183
    v_cvt_pk_bf16_f32 v184, v184, v185
    v_cvt_pk_bf16_f32 v185, v186, v187
    v_cvt_pk_bf16_f32 v186, v188, v189
    v_cvt_pk_bf16_f32 v187, v190, v191
    s_waitcnt lgkmcnt(4)
    v_mfma_f32_32x32x16_bf16 v[48:63], v[40:43], v[176:179], v[48:63]
    v_mfma_f32_32x32x16_bf16 v[48:63], v[44:47], v[184:187], v[48:63]
    ds_read_b64_tr_b16 v[40:41], v74 offset:3584
    ds_read_b64_tr_b16 v[42:43], v74 offset:3712
    ds_read_b64_tr_b16 v[44:45], v74 offset:3840
    ds_read_b64_tr_b16 v[46:47], v74 offset:3968
    v_pk_add_f32 v[192:193], v[192:193], v[80:81]
    v_pk_add_f32 v[194:195], v[194:195], v[80:81]
    v_pk_add_f32 v[196:197], v[196:197], v[80:81]
    v_pk_add_f32 v[198:199], v[198:199], v[80:81]
    v_pk_add_f32 v[200:201], v[200:201], v[80:81]
    v_pk_add_f32 v[202:203], v[202:203], v[80:81]
    v_pk_add_f32 v[204:205], v[204:205], v[80:81]
    v_pk_add_f32 v[206:207], v[206:207], v[80:81]
    v_exp_f32 v192, v192
    v_exp_f32 v193, v193
    v_exp_f32 v194, v194
    v_exp_f32 v195, v195
    v_exp_f32 v196, v196
    v_exp_f32 v197, v197
    v_exp_f32 v198, v198
    v_exp_f32 v199, v199
    v_exp_f32 v200, v200
    v_exp_f32 v201, v201
    v_exp_f32 v202, v202
    v_exp_f32 v203, v203
    v_exp_f32 v204, v204
    v_exp_f32 v205, v205
    v_exp_f32 v206, v206
    v_exp_f32 v207, v207
    v_cvt_pk_bf16_f32 v192, v192, v193
    v_cvt_pk_bf16_f32 v193, v194, v195
    v_cvt_pk_bf16_f32 v194, v196, v197
    v_cvt_pk_bf16_f32 v195, v198, v199
    v_cvt_pk_bf16_f32 v200, v200, v201
    v_cvt_pk_bf16_f32 v201, v202, v203
    v_cvt_pk_bf16_f32 v202, v204, v205
    v_cvt_pk_bf16_f32 v203, v206, v207
    s_waitcnt lgkmcnt(4)
    v_mfma_f32_32x32x16_bf16 v[48:63], v[32:35], v[192:195], v[48:63]
    v_mfma_f32_32x32x16_bf16 v[48:63], v[36:39], v[200:203], v[48:63]
    ds_read_b64_tr_b16 v[32:33], v74 offset:4096
    ds_read_b64_tr_b16 v[34:35], v74 offset:4224
    ds_read_b64_tr_b16 v[36:37], v74 offset:4352
    ds_read_b64_tr_b16 v[38:39], v74 offset:4480
    v_pk_add_f32 v[208:209], v[208:209], v[80:81]
    v_pk_add_f32 v[210:211], v[210:211], v[80:81]
    v_pk_add_f32 v[212:213], v[212:213], v[80:81]
    v_pk_add_f32 v[214:215], v[214:215], v[80:81]
    v_pk_add_f32 v[216:217], v[216:217], v[80:81]
    v_pk_add_f32 v[218:219], v[218:219], v[80:81]
    v_pk_add_f32 v[220:221], v[220:221], v[80:81]
    v_pk_add_f32 v[222:223], v[222:223], v[80:81]
    v_exp_f32 v208, v208
    v_exp_f32 v209, v209
    v_exp_f32 v210, v210
    v_exp_f32 v211, v211
    v_exp_f32 v212, v212
    v_exp_f32 v213, v213
    v_exp_f32 v214, v214
    v_exp_f32 v215, v215
    v_exp_f32 v216, v216
    v_exp_f32 v217, v217
    v_exp_f32 v218, v218
    v_exp_f32 v219, v219
    v_exp_f32 v220, v220
    v_exp_f32 v221, v221
    v_exp_f32 v222, v222
    v_exp_f32 v223, v223
    v_cvt_pk_bf16_f32 v208, v208, v209
    v_cvt_pk_bf16_f32 v209, v210, v211
    v_cvt_pk_bf16_f32 v210, v212, v213
    v_cvt_pk_bf16_f32 v211, v214, v215
    v_cvt_pk_bf16_f32 v216, v216, v217
    v_cvt_pk_bf16_f32 v217, v218, v219
    v_cvt_pk_bf16_f32 v218, v220, v221
    v_cvt_pk_bf16_f32 v219, v222, v223
    s_waitcnt lgkmcnt(4)
    v_mfma_f32_32x32x16_bf16 v[48:63], v[40:43], v[208:211], v[48:63]
    v_mfma_f32_32x32x16_bf16 v[48:63], v[44:47], v[216:219], v[48:63]
    s_waitcnt lgkmcnt(0)
    v_mfma_f32_32x32x16_bf16 v[48:63], v[32:35], v[224:227], v[48:63]
    v_mfma_f32_32x32x16_bf16 v[48:63], v[36:39], v[228:231], v[48:63]
    s_branch L_norm_73
L_fix_79:
    s_nop 15
    v_mov_b32 v79, 0xf149f2ca
    s_cmp_gt_u32 s52, 7
    s_cbranch_scc1 L_fs_81
    v_mov_b32 v96, v79
    v_mov_b32 v97, v79
    v_mov_b32 v98, v79
    v_mov_b32 v99, v79
    v_mov_b32 v100, v79
    v_mov_b32 v101, v79
    v_mov_b32 v102, v79
    v_mov_b32 v103, v79
    v_mov_b32 v104, v79
    v_mov_b32 v105, v79
    v_mov_b32 v106, v79
    v_mov_b32 v107, v79
    v_mov_b32 v108, v79
    v_mov_b32 v109, v79
    v_mov_b32 v110, v79
    v_mov_b32 v111, v79
L_fs_81:
    s_cmp_gt_u32 s52, 6
    s_cbranch_scc1 L_fs_82
    v_mov_b32 v112, v79
    v_mov_b32 v113, v79
    v_mov_b32 v114, v79
    v_mov_b32 v115, v79
    v_mov_b32 v116, v79
    v_mov_b32 v117, v79
    v_mov_b32 v118, v79
    v_mov_b32 v119, v79
    v_mov_b32 v120, v79
    v_mov_b32 v121, v79
    v_mov_b32 v122, v79
    v_mov_b32 v123, v79
    v_mov_b32 v124, v79
    v_mov_b32 v125, v79
    v_mov_b32 v126, v79
    v_mov_b32 v127, v79
L_fs_82:
    s_cmp_gt_u32 s52, 5
    s_cbranch_scc1 L_fs_83
    v_mov_b32 v128, v79
    v_mov_b32 v129, v79
    v_mov_b32 v130, v79
    v_mov_b32 v131, v79
    v_mov_b32 v132, v79
    v_mov_b32 v133, v79
    v_mov_b32 v134, v79
    v_mov_b32 v135, v79
    v_mov_b32 v136, v79
    v_mov_b32 v137, v79
    v_mov_b32 v138, v79
    v_mov_b32 v139, v79
    v_mov_b32 v140, v79
    v_mov_b32 v141, v79
    v_mov_b32 v142, v79
    v_mov_b32 v143, v79
L_fs_83:
    s_cmp_gt_u32 s52, 4
    s_cbranch_scc1 L_fs_84
    v_mov_b32 v144, v79
    v_mov_b32 v145, v79
    v_mov_b32 v146, v79
    v_mov_b32 v147, v79
    v_mov_b32 v148, v79
    v_mov_b32 v149, v79
    v_mov_b32 v150, v79
    v_mov_b32 v151, v79
    v_mov_b32 v152, v79
    v_mov_b32 v153, v79
    v_mov_b32 v154, v79
    v_mov_b32 v155, v79
    v_mov_b32 v156, v79
    v_mov_b32 v157, v79
    v_mov_b32 v158, v79
    v_mov_b32 v159, v79
L_fs_84:
    s_cmp_gt_u32 s52, 3
    s_cbranch_scc1 L_fs_85
    v_mov_b32 v160, v79
    v_mov_b32 v161, v79
    v_mov_b32 v162, v79
    v_mov_b32 v163, v79
    v_mov_b32 v164, v79
    v_mov_b32 v165, v79
    v_mov_b32 v166, v79
    v_mov_b32 v167, v79
    v_mov_b32 v168, v79
    v_mov_b32 v169, v79
    v_mov_b32 v170, v79
    v_mov_b32 v171, v79
    v_mov_b32 v172, v79
    v_mov_b32 v173, v79
    v_mov_b32 v174, v79
    v_mov_b32 v175, v79
L_fs_85:
    s_cmp_gt_u32 s52, 2
    s_cbranch_scc1 L_fs_86
    v_mov_b32 v176, v79
    v_mov_b32 v177, v79
    v_mov_b32 v178, v79
    v_mov_b32 v179, v79
    v_mov_b32 v180, v79
    v_mov_b32 v181, v79
    v_mov_b32 v182, v79
    v_mov_b32 v183, v79
    v_mov_b32 v184, v79
    v_mov_b32 v185, v79
    v_mov_b32 v186, v79
    v_mov_b32 v187, v79
    v_mov_b32 v188, v79
    v_mov_b32 v189, v79
    v_mov_b32 v190, v79
    v_mov_b32 v191, v79
L_fs_86:
    s_cmp_gt_u32 s52, 1
    s_cbranch_scc1 L_fs_87
    v_mov_b32 v192, v79
    v_mov_b32 v193, v79
    v_mov_b32 v194, v79
    v_mov_b32 v195, v79
    v_mov_b32 v196, v79
    v_mov_b32 v197, v79
    v_mov_b32 v198, v79
    v_mov_b32 v199, v79
    v_mov_b32 v200, v79
    v_mov_b32 v201, v79
    v_mov_b32 v202, v79
    v_mov_b32 v203, v79
    v_mov_b32 v204, v79
    v_mov_b32 v205, v79
    v_mov_b32 v206, v79
    v_mov_b32 v207, v79
L_fs_87:
    s_cmp_gt_u32 s52, 0
    s_cbranch_scc1 L_fs_88
    v_mov_b32 v208, v79
    v_mov_b32 v209, v79
    v_mov_b32 v210, v79
    v_mov_b32 v211, v79
    v_mov_b32 v212, v79
    v_mov_b32 v213, v79
    v_mov_b32 v214, v79
    v_mov_b32 v215, v79
    v_mov_b32 v216, v79
    v_mov_b32 v217, v79
    v_mov_b32 v218, v79
    v_mov_b32 v219, v79
    v_mov_b32 v220, v79
    v_mov_b32 v221, v79
    v_mov_b32 v222, v79
    v_mov_b32 v223, v79
L_fs_88:
    s_branch L_ret_80
L_P3:
    s_cmp_ge_u32 s41, 30
    s_cbranch_scc1 L_CS1
    s_mul_i32 s45, s41, 26
    s_lshr_b32 s45, s45, 8
    s_mul_i32 s52, s45, 10
    s_sub_u32 s46, s41, s52
    s_mul_i32 s52, s45, 96
    s_lshl_b32 s43, s40, 8
    s_add_u32 s43, s43, s52
    s_cmp_lt_u32 s42, 4
    s_cbranch_scc1 L_C3
    s_cmp_eq_u32 s42, 6
    s_cbranch_scc1 L_S3
    s_cmp_eq_u32 s42, 7
    s_cbranch_scc1 L_X3
    v_lshrrev_b32 v2, 5, v0
    v_and_b32 v3, 31, v0
    v_lshlrev_b32 v2, 15, v2
    v_lshl_add_u32 v8, v3, 4, v2
    v_add_u32 v9, 512, v8
    v_add_u32 v10, 1024, v8
    v_add_u32 v11, 65536, v8
    v_add_u32 v12, 66048, v8
    v_add_u32 v13, 66560, v8
    v_add_u32 v14, 131072, v8
    v_add_u32 v15, 131584, v8
    v_add_u32 v16, 132096, v8
    v_add_u32 v17, 196608, v8
    v_add_u32 v18, 197120, v8
    v_add_u32 v19, 197632, v8
    s_and_b32 s54, s42, 1
    s_lshl_b32 s47, s54, 18
    s_lshl_b32 s52, s43, 4
    s_add_u32 s47, s47, s52
    s_add_u32 s47, s47, 1048576
    s_mul_i32 s63, s54, 12288
    s_setprio 3
    s_barrier
    s_add_u32 s52, s63, 0
    s_add_u32 m0, s52, 0
    s_nop 0
    buffer_load_dwordx4 v8, s[32:35], s47 offen sc1 lds
    s_add_u32 m0, m0, s62
    s_nop 0
    buffer_load_dwordx4 v9, s[32:35], s47 offen sc1 lds
    s_add_u32 m0, m0, s62
    s_nop 0
    buffer_load_dwordx4 v10, s[32:35], s47 offen sc1 lds
    s_add_u32 m0, m0, s62
    s_nop 0
    buffer_load_dwordx4 v11, s[32:35], s47 offen sc1 lds
    s_add_u32 m0, m0, s62
    s_nop 0
    buffer_load_dwordx4 v12, s[32:35], s47 offen sc1 lds
    s_add_u32 m0, m0, s62
    s_nop 0
    buffer_load_dwordx4 v13, s[32:35], s47 offen sc1 lds
    s_add_u32 m0, m0, s62
    s_nop 0
    buffer_load_dwordx4 v14, s[32:35], s47 offen sc1 lds
    s_add_u32 m0, m0, s62
    s_nop 0
    buffer_load_dwordx4 v15, s[32:35], s47 offen sc1 lds
    s_add_u32 m0, m0, s62
    s_nop 0
    buffer_load_dwordx4 v16, s[32:35], s47 offen sc1 lds
    s_add_u32 m0, m0, s62
    s_nop 0
    buffer_load_dwordx4 v17, s[32:35], s47 offen sc1 lds
    s_add_u32 m0, m0, s62
    s_nop 0
    buffer_load_dwordx4 v18, s[32:35], s47 offen sc1 lds
    s_add_u32 m0, m0, s62
    s_nop 0
    buffer_load_dwordx4 v19, s[32:35], s47 offen sc1 lds
    s_add_u32 s47, s47, 524288
    s_add_u32 s52, s63, 24576
    s_add_u32 m0, s52, 0
    s_nop 0
    buffer_load_dwordx4 v8, s[32:35], s47 offen sc1 lds
    s_add_u32 m0, m0, s62
    s_nop 0
    buffer_load_dwordx4 v9, s[32:35], s47 offen sc1 lds
    s_add_u32 m0, m0, s62
    s_nop 0
    buffer_load_dwordx4 v10, s[32:35], s47 offen sc1 lds
    s_add_u32 m0, m0, s62
    s_nop 0
    buffer_load_dwordx4 v11, s[32:35], s47 offen sc1 lds
    s_add_u32 m0, m0, s62
    s_nop 0
    buffer_load_dwordx4 v12, s[32:35], s47 offen sc1 lds
    s_add_u32 m0, m0, s62
    s_nop 0
    buffer_load_dwordx4 v13, s[32:35], s47 offen sc1 lds
    s_add_u32 m0, m0, s62
    s_nop 0
    buffer_load_dwordx4 v14, s[32:35], s47 offen sc1 lds
    s_add_u32 m0, m0, s62
    s_nop 0
    buffer_load_dwordx4 v15, s[32:35], s47 offen sc1 lds
    s_add_u32 m0, m0, s62
    s_nop 0
    buffer_load_dwordx4 v16, s[32:35], s47 offen sc1 lds
    s_add_u32 m0, m0, s62
    s_nop 0
    buffer_load_dwordx4 v17, s[32:35], s47 offen sc1 lds
    s_add_u32 m0, m0, s62
    s_nop 0
    buffer_load_dwordx4 v18, s[32:35], s47 offen sc1 lds
    s_add_u32 m0, m0, s62
    s_nop 0
    buffer_load_dwordx4 v19, s[32:35], s47 offen sc1 lds
    s_add_u32 s47, s47, 524288
    s_waitcnt vmcnt(12)
    s_barrier
    s_add_u32 s52, s63, 49152
    s_add_u32 m0, s52, 0
    s_nop 0
    buffer_load_dwordx4 v8, s[32:35], s47 offen sc1 lds
    s_add_u32 m0, m0, s62
    s_nop 0
    buffer_load_dwordx4 v9, s[32:35], s47 offen sc1 lds
    s_add_u32 m0, m0, s62
    s_nop 0
    buffer_load_dwordx4 v10, s[32:35], s47 offen sc1 lds
    s_add_u32 m0, m0, s62
    s_nop 0
    buffer_load_dwordx4 v11, s[32:35], s47 offen sc1 lds
    s_add_u32 m0, m0, s62
    s_nop 0
    buffer_load_dwordx4 v12, s[32:35], s47 offen sc1 lds
    s_add_u32 m0, m0, s62
    s_nop 0
    buffer_load_dwordx4 v13, s[32:35], s47 offen sc1 lds
    s_add_u32 m0, m0, s62
    s_nop 0
    buffer_load_dwordx4 v14, s[32:35], s47 offen sc1 lds
    s_add_u32 m0, m0, s62
    s_nop 0
    buffer_load_dwordx4 v15, s[32:35], s47 offen sc1 lds
    s_add_u32 m0, m0, s62
    s_nop 0
    buffer_load_dwordx4 v16, s[32:35], s47 offen sc1 lds
    s_add_u32 m0, m0, s62
    s_nop 0
    buffer_load_dwordx4 v17, s[32:35], s47 offen sc1 lds
    s_add_u32 m0, m0, s62
    s_nop 0
    buffer_load_dwordx4 v18, s[32:35], s47 offen sc1 lds
    s_add_u32 m0, m0, s62
    s_nop 0
    buffer_load_dwordx4 v19, s[32:35], s47 offen sc1 lds
    s_add_u32 s47, s47, 524288
    s_waitcnt vmcnt(12)
    s_barrier
    s_add_u32 s52, s63, 0
    s_add_u32 m0, s52, 0
    s_nop 0
    buffer_load_dwordx4 v8, s[32:35], s47 offen sc1 lds
    s_add_u32 m0, m0, s62
    s_nop 0
    buffer_load_dwordx4 v9, s[32:35], s47 offen sc1 lds
    s_add_u32 m0, m0, s62
    s_nop 0
    buffer_load_dwordx4 v10, s[32:35], s47 offen sc1 lds
    s_add_u32 m0, m0, s62
    s_nop 0
    buffer_load_dwordx4 v11, s[32:35], s47 offen sc1 lds
    s_add_u32 m0, m0, s62
    s_nop 0
    buffer_load_dwordx4 v12, s[32:35], s47 offen sc1 lds
    s_add_u32 m0, m0, s62
    s_nop 0
    buffer_load_dwordx4 v13, s[32:35], s47 offen sc1 lds
    s_add_u32 m0, m0, s62
    s_nop 0
    buffer_load_dwordx4 v14, s[32:35], s47 offen sc1 lds
    s_add_u32 m0, m0, s62
    s_nop 0
    buffer_load_dwordx4 v15, s[32:35], s47 offen sc1 lds
    s_add_u32 m0, m0, s62
    s_nop 0
    buffer_load_dwordx4 v16, s[32:35], s47 offen sc1 lds
    s_add_u32 m0, m0, s62
    s_nop 0
    buffer_load_dwordx4 v17, s[32:35], s47 offen sc1 lds
    s_add_u32 m0, m0, s62
    s_nop 0
    buffer_load_dwordx4 v18, s[32:35], s47 offen sc1 lds
    s_add_u32 m0, m0, s62
    s_nop 0
    buffer_load_dwordx4 v19, s[32:35], s47 offen sc1 lds
    s_add_u32 s47, s47, 524288
    s_waitcnt vmcnt(12)
    s_barrier
    s_add_u32 s52, s63, 24576
    s_add_u32 m0, s52, 0
    s_nop 0
    buffer_load_dwordx4 v8, s[32:35], s47 offen sc1 lds
    s_add_u32 m0, m0, s62
    s_nop 0
    buffer_load_dwordx4 v9, s[32:35], s47 offen sc1 lds
    s_add_u32 m0, m0, s62
    s_nop 0
    buffer_load_dwordx4 v10, s[32:35], s47 offen sc1 lds
    s_add_u32 m0, m0, s62
    s_nop 0
    buffer_load_dwordx4 v11, s[32:35], s47 offen sc1 lds
    s_add_u32 m0, m0, s62
    s_nop 0
    buffer_load_dwordx4 v12, s[32:35], s47 offen sc1 lds
    s_add_u32 m0, m0, s62
    s_nop 0
    buffer_load_dwordx4 v13, s[32:35], s47 offen sc1 lds
    s_add_u32 m0, m0, s62
    s_nop 0
    buffer_load_dwordx4 v14, s[32:35], s47 offen sc1 lds
    s_add_u32 m0, m0, s62
    s_nop 0
    buffer_load_dwordx4 v15, s[32:35], s47 offen sc1 lds
    s_add_u32 m0, m0, s62
    s_nop 0
    buffer_load_dwordx4 v16, s[32:35], s47 offen sc1 lds
    s_add_u32 m0, m0, s62
    s_nop 0
    buffer_load_dwordx4 v17, s[32:35], s47 offen sc1 lds
    s_add_u32 m0, m0, s62
    s_nop 0
    buffer_load_dwordx4 v18, s[32:35], s47 offen sc1 lds
    s_add_u32 m0, m0, s62
    s_nop 0
    buffer_load_dwordx4 v19, s[32:35], s47 offen sc1 lds
    s_add_u32 s47, s47, 524288
    s_waitcnt vmcnt(12)
    s_barrier
    s_waitcnt vmcnt(0)
    s_barrier
    s_barrier
    s_lshr_b32 s45, s41, 3
    s_and_b32 s46, s41, 7
    s_lshl_b32 s43, s40, 8
    s_lshl_b32 s52, s45, 6
    s_add_u32 s43, s43, s52
    s_mul_i32 s44, s46, 192
    v_add_u32 v2, 0, v0
    v_mul_u32_u24 v3, 171, v2
    v_lshrrev_b32 v3, 12, v3
    v_mul_u32_u24 v4, 24, v3
    v_sub_u32 v4, v2, v4
    v_bfe_u32 v5, v3, 1, 1
    v_lshlrev_b32 v5, 2, v5
    v_xor_b32 v4, v4, v5
    v_and_b32 v5, 3, v3
    v_lshrrev_b32 v6, 2, v3
    v_lshl_add_u32 v5, v6, 3, v5
    v_mul_u32_u24 v5, 3072, v5
    v_lshl_add_u32 v8, v4, 4, v5
    v_add_u32 v2, 64, v0
    v_mul_u32_u24 v3, 171, v2
    v_lshrrev_b32 v3, 12, v3
    v_mul_u32_u24 v4, 24, v3
    v_sub_u32 v4, v2, v4
    v_bfe_u32 v5, v3, 1, 1
    v_lshlrev_b32 v5, 2, v5
    v_xor_b32 v4, v4, v5
    v_and_b32 v5, 3, v3
    v_lshrrev_b32 v6, 2, v3
    v_lshl_add_u32 v5, v6, 3, v5
    v_mul_u32_u24 v5, 3072, v5
    v_lshl_add_u32 v9, v4, 4, v5
    v_add_u32 v2, 128, v0
    v_mul_u32_u24 v3, 171, v2
    v_lshrrev_b32 v3, 12, v3
    v_mul_u32_u24 v4, 24, v3
    v_sub_u32 v4, v2, v4
    v_bfe_u32 v5, v3, 1, 1
    v_lshlrev_b32 v5, 2, v5
    v_xor_b32 v4, v4, v5
    v_and_b32 v5, 3, v3
    v_lshrrev_b32 v6, 2, v3
    v_lshl_add_u32 v5, v6, 3, v5
    v_mul_u32_u24 v5, 3072, v5
    v_lshl_add_u32 v10, v4, 4, v5
    v_add_u32 v11, 12288, v8
    v_add_u32 v12, 12288, v9
    v_add_u32 v13, 12288, v10
    v_add_u32 v14, 49152, v8
    v_add_u32 v15, 49152, v9
    v_add_u32 v16, 49152, v10
    v_add_u32 v17, 61440, v8
    v_add_u32 v18, 61440, v9
    v_add_u32 v19, 61440, v10
    v_lshrrev_b32 v2, 5, v0
    v_and_b32 v3, 31, v0
    v_lshlrev_b32 v2, 15, v2
    v_lshl_add_u32 v20, v3, 4, v2
    v_add_u32 v21, 512, v20
    v_add_u32 v22, 65536, v20
    v_add_u32 v23, 66048, v20
    s_and_b32 s51, s42, 1
    s_lshl_b32 s52, s44, 1
    s_add_u32 s28, s12, s52
    s_addc_u32 s29, s13, 0
    s_sub_u32 s30, 1966080, s52
    s_mov_b32 s31, 0x20000
    s_mul_i32 s48, s51, 98304
    s_lshl_b32 s47, s43, 4
    s_add_u32 s47, s47, 3670016
    s_mul_i32 s52, s51, 131072
    s_add_u32 s47, s47, s52
    s_mul_i32 s54, s51, 12288
    s_lshl_b32 s63, s51, 12
    s_add_u32 s63, s63, 24576
    s_barrier
    s_add_u32 s52, s54, 0
    s_add_u32 m0, s52, 0
    s_nop 0
    buffer_load_dwordx4 v8, s[28:31], s48 offen lds
    s_add_u32 m0, m0, s62
    s_nop 0
    buffer_load_dwordx4 v9, s[28:31], s48 offen lds
    s_add_u32 m0, m0, s62
    s_nop 0
    buffer_load_dwordx4 v10, s[28:31], s48 offen lds
    s_add_u32 m0, m0, s62
    s_nop 0
    buffer_load_dwordx4 v11, s[28:31], s48 offen lds
    s_add_u32 m0, m0, s62
    s_nop 0
    buffer_load_dwordx4 v12, s[28:31], s48 offen lds
    s_add_u32 m0, m0, s62
    s_nop 0
    buffer_load_dwordx4 v13, s[28:31], s48 offen lds
    s_add_u32 m0, m0, s62
    s_nop 0
    buffer_load_dwordx4 v14, s[28:31], s48 offen lds
    s_add_u32 m0, m0, s62
    s_nop 0
    buffer_load_dwordx4 v15, s[28:31], s48 offen lds
    s_add_u32 m0, m0, s62
    s_nop 0
    buffer_load_dwordx4 v16, s[28:31], s48 offen lds
    s_add_u32 m0, m0, s62
    s_nop 0
    buffer_load_dwordx4 v17, s[28:31], s48 offen lds
    s_add_u32 m0, m0, s62
    s_nop 0
    buffer_load_dwordx4 v18, s[28:31], s48 offen lds
    s_add_u32 m0, m0, s62
    s_nop 0
    buffer_load_dwordx4 v19, s[28:31], s48 offen lds
    s_add_u32 s48, s48, 196608
    s_add_u32 s52, s54, 32768
    s_add_u32 m0, s52, 0
    s_nop 0
    buffer_load_dwordx4 v8, s[28:31], s48 offen lds
    s_add_u32 m0, m0, s62
    s_nop 0
    buffer_load_dwordx4 v9, s[28:31], s48 offen lds
    s_add_u32 m0, m0, s62
    s_nop 0
    buffer_load_dwordx4 v10, s[28:31], s48 offen lds
    s_add_u32 m0, m0, s62
    s_nop 0
    buffer_load_dwordx4 v11, s[28:31], s48 offen lds
    s_add_u32 m0, m0, s62
    s_nop 0
    buffer_load_dwordx4 v12, s[28:31], s48 offen lds
    s_add_u32 m0, m0, s62
    s_nop 0
    buffer_load_dwordx4 v13, s[28:31], s48 offen lds
    s_add_u32 m0, m0, s62
    s_nop 0
    buffer_load_dwordx4 v14, s[28:31], s48 offen lds
    s_add_u32 m0, m0, s62
    s_nop 0
    buffer_load_dwordx4 v15, s[28:31], s48 offen lds
    s_add_u32 m0, m0, s62
    s_nop 0
    buffer_load_dwordx4 v16, s[28:31], s48 offen lds
    s_add_u32 m0, m0, s62
    s_nop 0
    buffer_load_dwordx4 v17, s[28:31], s48 offen lds
    s_add_u32 m0, m0, s62
    s_nop 0
    buffer_load_dwordx4 v18, s[28:31], s48 offen lds
    s_add_u32 m0, m0, s62
    s_nop 0
    buffer_load_dwordx4 v19, s[28:31], s48 offen lds
    s_add_u32 s48, s48, 196608
    s_barrier
    s_add_u32 s52, s54, 65536
    s_add_u32 m0, s52, 0
    s_nop 0
    buffer_load_dwordx4 v8, s[28:31], s48 offen lds
    s_add_u32 m0, m0, s62
    s_nop 0
    buffer_load_dwordx4 v9, s[28:31], s48 offen lds
    s_add_u32 m0, m0, s62
    s_nop 0
    buffer_load_dwordx4 v10, s[28:31], s48 offen lds
    s_add_u32 m0, m0, s62
    s_nop 0
    buffer_load_dwordx4 v11, s[28:31], s48 offen lds
    s_add_u32 m0, m0, s62
    s_nop 0
    buffer_load_dwordx4 v12, s[28:31], s48 offen lds
    s_add_u32 m0, m0, s62
    s_nop 0
    buffer_load_dwordx4 v13, s[28:31], s48 offen lds
    s_add_u32 m0, m0, s62
    s_nop 0
    buffer_load_dwordx4 v14, s[28:31], s48 offen lds
    s_add_u32 m0, m0, s62
    s_nop 0
    buffer_load_dwordx4 v15, s[28:31], s48 offen lds
    s_add_u32 m0, m0, s62
    s_nop 0
    buffer_load_dwordx4 v16, s[28:31], s48 offen lds
    s_add_u32 m0, m0, s62
    s_nop 0
    buffer_load_dwordx4 v17, s[28:31], s48 offen lds
    s_add_u32 m0, m0, s62
    s_nop 0
    buffer_load_dwordx4 v18, s[28:31], s48 offen lds
    s_add_u32 m0, m0, s62
    s_nop 0
    buffer_load_dwordx4 v19, s[28:31], s48 offen lds
    s_add_u32 s48, s48, 196608
    s_add_u32 s52, s54, 98304
    s_add_u32 m0, s52, 0
    s_nop 0
    buffer_load_dwordx4 v8, s[28:31], s48 offen lds
    s_add_u32 m0, m0, s62
    s_nop 0
    buffer_load_dwordx4 v9, s[28:31], s48 offen lds
    s_add_u32 m0, m0, s62
    s_nop 0
    buffer_load_dwordx4 v10, s[28:31], s48 offen lds
    s_add_u32 m0, m0, s62
    s_nop 0
    buffer_load_dwordx4 v11, s[28:31], s48 offen lds
    s_add_u32 m0, m0, s62
    s_nop 0
    buffer_load_dwordx4 v12, s[28:31], s48 offen lds
    s_add_u32 m0, m0, s62
    s_nop 0
    buffer_load_dwordx4 v13, s[28:31], s48 offen lds
    s_add_u32 m0, m0, s62
    s_nop 0
    buffer_load_dwordx4 v14, s[28:31], s48 offen lds
    s_add_u32 m0, m0, s62
    s_nop 0
    buffer_load_dwordx4 v15, s[28:31], s48 offen lds
    s_add_u32 m0, m0, s62
    s_nop 0
    buffer_load_dwordx4 v16, s[28:31], s48 offen lds
    s_add_u32 m0, m0, s62
    s_nop 0
    buffer_load_dwordx4 v17, s[28:31], s48 offen lds
    s_add_u32 m0, m0, s62
    s_nop 0
    buffer_load_dwordx4 v18, s[28:31], s48 offen lds
    s_add_u32 m0, m0, s62
    s_nop 0
    buffer_load_dwordx4 v19, s[28:31], s48 offen lds
    s_add_u32 s48, s48, 196608
    s_barrier
    s_branch L_L4B
L_S3:
    s_mov_b32 s52, 0xffff
    s_cmp_eq_u32 s45, 1
    s_cselect_b32 s52, -1, s52
    s_cmp_eq_u32 s45, 2
    s_cselect_b32 s52, 0xffff0000, s52
    s_mov_b32 s63, s52
    s_lshl_b32 s52, s40, 5
    s_load_dwordx8 s[64:71], s[18:19], s52
    s_add_u32 s52, s40, 1
    s_min_u32 s52, s52, 7
    s_lshl_b32 s52, s52, 5
    s_load_dwordx8 s[72:79], s[18:19], s52
    s_lshl_b32 s53, s40, 8
    s_add_u32 s53, s53, 32768
    v_and_b32 v2, 31, v0
    v_lshl_add_u32 v8, v2, 2, s53
    v_mov_b32 v3, s63
    v_lshrrev_b32 v3, v2, v3
    v_and_b32 v3, 1, v3
    v_mul_u32_u24 v9, 3, v3
L_poll_89:
    buffer_load_dword v10, v8, s[32:35], 0 offen sc1
L_poll_90:
    s_waitcnt vmcnt(0)
    v_cmp_lt_u32 s[60:61], v10, v9
    s_nop 2
    s_cmp_eq_u64 s[60:61], 0
    s_cbranch_scc0 L_poll_89
    s_barrier
    s_branch L_kf_92
L_kf_91:
    s_sleep 8
    s_lshl_b32 s52, s40, 5
    s_load_dwordx8 s[64:71], s[18:19], s52 glc
    s_add_u32 s52, s40, 1
    s_min_u32 s52, s52, 7
    s_lshl_b32 s52, s52, 5
    s_load_dwordx8 s[72:79], s[18:19], s52 glc
L_kf_92:
    s_waitcnt lgkmcnt(0)
    s_mov_b32 s52, 0x40404040
    s_and_b32 s52, s52, s64
    s_and_b32 s52, s52, s65
    s_and_b32 s52, s52, s66
    s_and_b32 s52, s52, s67
    s_and_b32 s52, s52, s68
    s_and_b32 s52, s52, s69
    s_and_b32 s52, s52, s70
    s_and_b32 s52, s52, s71
    s_and_b32 s52, s52, s72
    s_and_b32 s52, s52, s73
    s_and_b32 s52, s52, s74
    s_and_b32 s52, s52, s75
    s_and_b32 s52, s52, s76
    s_and_b32 s52, s52, s77
    s_and_b32 s52, s52, s78
    s_and_b32 s52, s52, s79
    s_cmp_eq_u32 s52, 0x40404040
    s_cbranch_scc0 L_kf_91
    s_barrier
    s_mov_b32 s51, 0
L_S3LOOP:
    s_barrier
    s_add_u32 s51, s51, 1
    s_cmp_lt_u32 s51, 5
    s_cbranch_scc1 L_S3LOOP
    s_barrier
    s_barrier
    s_barrier
    s_lshl_b32 s52, s40, 8
    s_lshl_b32 s53, s41, 2
    s_add_u32 s52, s52, s53
    s_add_u32 s52, s52, 32768
    v_mov_b32 v2, 4
    v_mov_b32 v3, 0
    s_mov_b64 exec, 1
    s_cmp_eq_u32 s56, 1
    s_cbranch_scc1 L_sm_93
    buffer_store_dword v2, v3, s[32:35], s52 offen sc1
    s_branch L_sm_94
L_sm_93:
    buffer_store_dword v2, v3, s[32:35], s52 offen
L_sm_94:
    s_mov_b64 exec, -1
    s_branch L_P4
L_X3:
    s_barrier
    s_barrier
    s_mov_b32 s51, 0
L_X3LOOP:
    s_barrier
    s_add_u32 s51, s51, 1
    s_cmp_lt_u32 s51, 5
    s_cbranch_scc1 L_X3LOOP
    s_barrier
    s_barrier
    v_lshlrev_b32 v2, 3, v0
    v_add_u32 v3, 155648, v2
    ds_read_b64 v[8:9], v3 offset:0
    ds_read_b64 v[10:11], v3 offset:768
    ds_read_b64 v[12:13], v3 offset:1536
    ds_read_b64 v[14:15], v3 offset:2304
    s_waitcnt lgkmcnt(0)
    v_add_f32 v8, v8, v10
    v_add_f32 v9, v9, v11
    v_add_f32 v12, v12, v14
    v_add_f32 v13, v13, v15
    v_add_f32 v8, v8, v12
    v_add_f32 v9, v9, v13
    s_lshl_b32 s52, s46, 14
    s_lshl_b32 s53, s43, 3
    s_add_u32 s52, s52, s53
    s_add_u32 s52, s52, 131072
    buffer_store_dwordx2 v[8:9], v2, s[32:35], s52 offen sc1
    v_lshlrev_b32 v2, 3, v0
    v_add_u32 v3, 155648, v2
    ds_read_b64 v[8:9], v3 offset:512
    ds_read_b64 v[10:11], v3 offset:1280
    ds_read_b64 v[12:13], v3 offset:2048
    ds_read_b64 v[14:15], v3 offset:2816
    s_waitcnt lgkmcnt(0)
    v_add_f32 v8, v8, v10
    v_add_f32 v9, v9, v11
    v_add_f32 v12, v12, v14
    v_add_f32 v13, v13, v15
    v_add_f32 v8, v8, v12
    v_add_f32 v9, v9, v13
    s_lshl_b32 s52, s46, 14
    s_lshl_b32 s53, s43, 3
    s_add_u32 s52, s52, s53
    s_add_u32 s52, s52, 131584
    s_cmp_eq_u32 s45, 2
    s_cbranch_scc1 L_x3_95
    s_mov_b32 exec_hi, 0
    buffer_store_dwordx2 v[8:9], v2, s[32:35], s52 offen sc1
    s_mov_b32 exec_hi, -1
L_x3_95:
    s_waitcnt vmcnt(0)
    s_barrier
    s_branch L_P4
L_C3:
    v_and_b32 v1, 31, v0
    v_lshrrev_b32 v2, 5, v0
    v_add_u32 v3, s43, v1
    v_mul_u32_u24 v4, 1280, v3
    s_lshl_b32 s52, s46, 6
    s_and_b32 s53, s42, 1
    s_lshl_b32 s53, s53, 5
    s_add_u32 s52, s52, s53
    s_lshr_b32 s53, s42, 1
    s_lshl_b32 s53, s53, 4
    s_add_u32 s44, s52, s53
    v_lshl_add_u32 v5, v2, 2, s44
    v_lshl_add_u32 v4, v5, 1, v4
    s_mov_b32 s36, s4
    s_mov_b32 s37, s5
    s_mov_b32 s38, 2621440
    s_mov_b32 s39, 0x20000
    s_mov_b32 s52, 0
    buffer_load_dwordx2 v[144:145], v4, s[36:39], s52 offen offset:0
    buffer_load_dwordx2 v[146:147], v4, s[36:39], s52 offen offset:16
    s_mov_b32 s52, 40960
    buffer_load_dwordx2 v[148:149], v4, s[36:39], s52 offen offset:0
    buffer_load_dwordx2 v[150:151], v4, s[36:39], s52 offen offset:16
    s_mov_b32 s52, 81920
    buffer_load_dwordx2 v[152:153], v4, s[36:39], s52 offen offset:0
    buffer_load_dwordx2 v[154:155], v4, s[36:39], s52 offen offset:16
    s_lshr_b32 s52, s44, 3
    v_add_u32 v5, s52, v2
    v_lshlrev_b32 v5, 15, v5
    v_lshl_add_u32 v5, v3, 4, v5
    v_add_u32 v20, 3670016, v5
    v_lshrrev_b32 v2, 5, v0
    v_bfe_u32 v3, v0, 2, 2
    v_bfe_u32 v4, v0, 4, 1
    v_lshlrev_b32 v4, 1, v4
    v_bfe_u32 v5, v0, 1, 1
    v_or_b32 v4, v4, v5
    s_and_b32 s52, s42, 1
    s_lshl_b32 s52, s52, 2
    v_or_b32 v4, s52, v4
    v_bfe_u32 v5, v0, 3, 1
    v_lshlrev_b32 v5, 2, v5
    v_xor_b32 v4, v4, v5
    v_lshlrev_b32 v4, 4, v4
    v_lshl_add_u32 v4, v3, 7, v4
    v_and_b32 v5, 1, v0
    v_lshl_add_u32 v4, v5, 3, v4
    v_mul_u32_u24 v5, 1024, v2
    v_add_u32 v4, v4, v5
    v_add_u32 v16, 81920, v4
    s_lshr_b32 s52, s42, 1
    s_lshl_b32 s53, s52, 11
    v_add_u32 v16, s53, v16
    s_mul_i32 s52, s52, 3072
    v_lshl_add_u32 v18, v0, 4, s52
    v_mov_b64 v[64:65], 0
    v_mov_b64 v[66:67], 0
    v_mov_b64 v[68:69], 0
    v_mov_b64 v[70:71], 0
    v_mov_b64 v[72:73], 0
    v_mov_b64 v[74:75], 0
    v_mov_b64 v[76:77], 0
    v_mov_b64 v[78:79], 0
    v_mov_b64 v[80:81], 0
    v_mov_b64 v[82:83], 0
    v_mov_b64 v[84:85], 0
    v_mov_b64 v[86:87], 0
    v_mov_b64 v[88:89], 0
    v_mov_b64 v[90:91], 0
    v_mov_b64 v[92:93], 0
    v_mov_b64 v[94:95], 0
    v_mov_b64 v[96:97], 0
    v_mov_b64 v[98:99], 0
    v_mov_b64 v[100:101], 0
    v_mov_b64 v[102:103], 0
    v_mov_b64 v[104:105], 0
    v_mov_b64 v[106:107], 0
    v_mov_b64 v[108:109], 0
    v_mov_b64 v[110:111], 0
    s_barrier
    s_mov_b32 s49, 0
    s_mov_b32 s48, 0
    s_mov_b32 s51, 0
    v_add_u32 v19, s49, v18
    v_add_u32 v17, s48, v16
    s_barrier
    ds_read_b64_tr_b16 v[112:113], v17 offset:0
    ds_read_b64_tr_b16 v[114:115], v17 offset:512
    ds_read_b128 v[120:123], v19 offset:0
    ds_read_b128 v[124:127], v19 offset:1024
    ds_read_b128 v[128:131], v19 offset:2048
L_B3LOOP:
    s_waitcnt lgkmcnt(0)
    v_mfma_f32_32x32x16_bf16 v[64:79], v[112:115], v[120:123], v[64:79]
    ds_read_b64_tr_b16 v[116:117], v17 offset:4096
    ds_read_b64_tr_b16 v[118:119], v17 offset:4608
    v_mfma_f32_32x32x16_bf16 v[80:95], v[112:115], v[124:127], v[80:95]
    ds_read_b128 v[132:135], v19 offset:6144
    ds_read_b128 v[136:139], v19 offset:7168
    ds_read_b128 v[140:143], v19 offset:8192
    v_mfma_f32_32x32x16_bf16 v[96:111], v[112:115], v[128:131], v[96:111]
    s_waitcnt lgkmcnt(0)
    v_mfma_f32_32x32x16_bf16 v[64:79], v[116:119], v[132:135], v[64:79]
    ds_read_b64_tr_b16 v[112:113], v17 offset:8192
    ds_read_b64_tr_b16 v[114:115], v17 offset:8704
    v_mfma_f32_32x32x16_bf16 v[80:95], v[116:119], v[136:139], v[80:95]
    ds_read_b128 v[120:123], v19 offset:12288
    ds_read_b128 v[124:127], v19 offset:13312
    ds_read_b128 v[128:131], v19 offset:14336
    v_mfma_f32_32x32x16_bf16 v[96:111], v[116:119], v[140:143], v[96:111]
    s_waitcnt lgkmcnt(0)
    v_mfma_f32_32x32x16_bf16 v[64:79], v[112:115], v[120:123], v[64:79]
    ds_read_b64_tr_b16 v[116:117], v17 offset:12288
    ds_read_b64_tr_b16 v[118:119], v17 offset:12800
    v_mfma_f32_32x32x16_bf16 v[80:95], v[112:115], v[124:127], v[80:95]
    ds_read_b128 v[132:135], v19 offset:18432
    ds_read_b128 v[136:139], v19 offset:19456
    ds_read_b128 v[140:143], v19 offset:20480
    s_add_u32 s49, s49, 24576
    s_cmp_eq_u32 s49, 73728
    s_cselect_b32 s49, 0, s49
    s_add_u32 s48, s48, 16384
    v_mfma_f32_32x32x16_bf16 v[96:111], v[112:115], v[128:131], v[96:111]
    v_add_u32 v19, s49, v18
    v_add_u32 v17, s48, v16
    s_waitcnt lgkmcnt(0)
    s_barrier
    v_mfma_f32_32x32x16_bf16 v[64:79], v[116:119], v[132:135], v[64:79]
    ds_read_b64_tr_b16 v[112:113], v17 offset:0
    ds_read_b64_tr_b16 v[114:115], v17 offset:512
    v_mfma_f32_32x32x16_bf16 v[80:95], v[116:119], v[136:139], v[80:95]
    ds_read_b128 v[120:123], v19 offset:0
    ds_read_b128 v[124:127], v19 offset:1024
    ds_read_b128 v[128:131], v19 offset:2048
    v_mfma_f32_32x32x16_bf16 v[96:111], v[116:119], v[140:143], v[96:111]
    s_add_u32 s51, s51, 1
    s_cmp_lt_u32 s51, 5
    s_cbranch_scc1 L_B3LOOP
    s_mul_i32 s52, s42, 6144
    s_add_u32 s52, s52, 131072
    v_lshl_add_u32 v2, v0, 4, s52
    s_xor_b32 s52, s42, 2
    s_mul_i32 s52, s52, 6144
    s_add_u32 s52, s52, 131072
    v_lshl_add_u32 v3, v0, 4, s52
    s_cmp_ge_u32 s42, 2
    s_cbranch_scc1 L_k1_96
    ds_write_b128 v2, v[72:75] offset:0
    ds_write_b128 v2, v[76:79] offset:1024
    ds_write_b128 v2, v[88:91] offset:2048
    ds_write_b128 v2, v[92:95] offset:3072
    ds_write_b128 v2, v[104:107] offset:4096
    ds_write_b128 v2, v[108:111] offset:5120
    s_waitcnt lgkmcnt(0)
    s_barrier
    ds_read_b128 v[160:163], v3 offset:0
    ds_read_b128 v[164:167], v3 offset:1024
    ds_read_b128 v[168:171], v3 offset:2048
    ds_read_b128 v[172:175], v3 offset:3072
    ds_read_b128 v[176:179], v3 offset:4096
    ds_read_b128 v[180:183], v3 offset:5120
    s_waitcnt lgkmcnt(0)
    v_pk_add_f32 v[160:161], v[160:161], v[64:65]
    v_pk_add_f32 v[162:163], v[162:163], v[66:67]
    v_pk_add_f32 v[164:165], v[164:165], v[68:69]
    v_pk_add_f32 v[166:167], v[166:167], v[70:71]
    v_pk_add_f32 v[168:169], v[168:169], v[80:81]
    v_pk_add_f32 v[170:171], v[170:171], v[82:83]
    v_pk_add_f32 v[172:173], v[172:173], v[84:85]
    v_pk_add_f32 v[174:175], v[174:175], v[86:87]
    v_pk_add_f32 v[176:177], v[176:177], v[96:97]
    v_pk_add_f32 v[178:179], v[178:179], v[98:99]
    v_pk_add_f32 v[180:181], v[180:181], v[100:101]
    v_pk_add_f32 v[182:183], v[182:183], v[102:103]
    s_branch L_kj_97
L_k1_96:
    ds_write_b128 v2, v[64:67] offset:0
    ds_write_b128 v2, v[68:71] offset:1024
    ds_write_b128 v2, v[80:83] offset:2048
    ds_write_b128 v2, v[84:87] offset:3072
    ds_write_b128 v2, v[96:99] offset:4096
    ds_write_b128 v2, v[100:103] offset:5120
    s_waitcnt lgkmcnt(0)
    s_barrier
    ds_read_b128 v[160:163], v3 offset:0
    ds_read_b128 v[164:167], v3 offset:1024
    ds_read_b128 v[168:171], v3 offset:2048
    ds_read_b128 v[172:175], v3 offset:3072
    ds_read_b128 v[176:179], v3 offset:4096
    ds_read_b128 v[180:183], v3 offset:5120
    s_waitcnt lgkmcnt(0)
    v_pk_add_f32 v[160:161], v[160:161], v[72:73]
    v_pk_add_f32 v[162:163], v[162:163], v[74:75]
    v_pk_add_f32 v[164:165], v[164:165], v[76:77]
    v_pk_add_f32 v[166:167], v[166:167], v[78:79]
    v_pk_add_f32 v[168:169], v[168:169], v[88:89]
    v_pk_add_f32 v[170:171], v[170:171], v[90:91]
    v_pk_add_f32 v[172:173], v[172:173], v[92:93]
    v_pk_add_f32 v[174:175], v[174:175], v[94:95]
    v_pk_add_f32 v[176:177], v[176:177], v[104:105]
    v_pk_add_f32 v[178:179], v[178:179], v[106:107]
    v_pk_add_f32 v[180:181], v[180:181], v[108:109]
    v_pk_add_f32 v[182:183], v[182:183], v[110:111]
L_kj_97:
    s_waitcnt vmcnt(0)
    v_lshlrev_b32 v2, 16, v144
    v_and_b32 v3, 0xffff0000, v144
    v_add_f32 v160, v160, v2
    v_add_f32 v161, v161, v3
    v_cvt_pk_bf16_f32 v240, v160, v161
    v_lshlrev_b32 v2, 16, v145
    v_and_b32 v3, 0xffff0000, v145
    v_add_f32 v162, v162, v2
    v_add_f32 v163, v163, v3
    v_cvt_pk_bf16_f32 v241, v162, v163
    v_lshlrev_b32 v2, 16, v146
    v_and_b32 v3, 0xffff0000, v146
    v_add_f32 v164, v164, v2
    v_add_f32 v165, v165, v3
    v_cvt_pk_bf16_f32 v242, v164, v165
    v_lshlrev_b32 v2, 16, v147
    v_and_b32 v3, 0xffff0000, v147
    v_add_f32 v166, v166, v2
    v_add_f32 v167, v167, v3
    v_cvt_pk_bf16_f32 v243, v166, v167
    v_lshlrev_b32 v2, 16, v148
    v_and_b32 v3, 0xffff0000, v148
    v_add_f32 v168, v168, v2
    v_add_f32 v169, v169, v3
    v_cvt_pk_bf16_f32 v244, v168, v169
    v_lshlrev_b32 v2, 16, v149
    v_and_b32 v3, 0xffff0000, v149
    v_add_f32 v170, v170, v2
    v_add_f32 v171, v171, v3
    v_cvt_pk_bf16_f32 v245, v170, v171
    v_lshlrev_b32 v2, 16, v150
    v_and_b32 v3, 0xffff0000, v150
    v_add_f32 v172, v172, v2
    v_add_f32 v173, v173, v3
    v_cvt_pk_bf16_f32 v246, v172, v173
    v_lshlrev_b32 v2, 16, v151
    v_and_b32 v3, 0xffff0000, v151
    v_add_f32 v174, v174, v2
    v_add_f32 v175, v175, v3
    v_cvt_pk_bf16_f32 v247, v174, v175
    v_lshlrev_b32 v2, 16, v152
    v_and_b32 v3, 0xffff0000, v152
    v_add_f32 v176, v176, v2
    v_add_f32 v177, v177, v3
    v_cvt_pk_bf16_f32 v248, v176, v177
    v_lshlrev_b32 v2, 16, v153
    v_and_b32 v3, 0xffff0000, v153
    v_add_f32 v178, v178, v2
    v_add_f32 v179, v179, v3
    v_cvt_pk_bf16_f32 v249, v178, v179
    v_lshlrev_b32 v2, 16, v154
    v_and_b32 v3, 0xffff0000, v154
    v_add_f32 v180, v180, v2
    v_add_f32 v181, v181, v3
    v_cvt_pk_bf16_f32 v250, v180, v181
    v_lshlrev_b32 v2, 16, v155
    v_and_b32 v3, 0xffff0000, v155
    v_add_f32 v182, v182, v2
    v_add_f32 v183, v183, v3
    v_cvt_pk_bf16_f32 v251, v182, v183
    v_mov_b32 v4, 0x3f803f80
    v_mov_b32 v24, 0
    v_mov_b32 v25, 0
    v_mov_b32 v26, 0
    v_mov_b32 v27, 0
    v_mov_b32 v28, 0
    v_mov_b32 v29, 0
    v_dot2_f32_bf16 v24, v240, v4, v24
    v_dot2_f32_bf16 v25, v240, v240, v25
    v_dot2_f32_bf16 v26, v244, v4, v26
    v_dot2_f32_bf16 v27, v244, v244, v27
    v_dot2_f32_bf16 v28, v248, v4, v28
    v_dot2_f32_bf16 v29, v248, v248, v29
    v_dot2_f32_bf16 v24, v241, v4, v24
    v_dot2_f32_bf16 v25, v241, v241, v25
    v_dot2_f32_bf16 v26, v245, v4, v26
    v_dot2_f32_bf16 v27, v245, v245, v27
    v_dot2_f32_bf16 v28, v249, v4, v28
    v_dot2_f32_bf16 v29, v249, v249, v29
    v_dot2_f32_bf16 v24, v242, v4, v24
    v_dot2_f32_bf16 v25, v242, v242, v25
    v_dot2_f32_bf16 v26, v246, v4, v26
    v_dot2_f32_bf16 v27, v246, v246, v27
    v_dot2_f32_bf16 v28, v250, v4, v28
    v_dot2_f32_bf16 v29, v250, v250, v29
    v_dot2_f32_bf16 v24, v243, v4, v24
    v_dot2_f32_bf16 v25, v243, v243, v25
    v_dot2_f32_bf16 v26, v247, v4, v26
    v_dot2_f32_bf16 v27, v247, v247, v27
    v_dot2_f32_bf16 v28, v251, v4, v28
    v_dot2_f32_bf16 v29, v251, v251, v29
    v_mov_b32 v32, v24
    v_mov_b32 v33, v25
    v_mov_b32 v34, v26
    v_mov_b32 v35, v27
    v_mov_b32 v36, v28
    v_mov_b32 v37, v29
    v_permlane32_swap_b32 v24, v32
    v_permlane32_swap_b32 v25, v33
    v_permlane32_swap_b32 v26, v34
    v_permlane32_swap_b32 v27, v35
    v_permlane32_swap_b32 v28, v36
    v_permlane32_swap_b32 v29, v37
    v_add_f32 v24, v24, v32
    v_add_f32 v25, v25, v33
    v_add_f32 v26, v26, v34
    v_add_f32 v27, v27, v35
    v_add_f32 v28, v28, v36
    v_add_f32 v29, v29, v37
    s_mul_i32 s52, s42, 768
    s_add_u32 s52, s52, 155648
    v_lshl_add_u32 v2, v1, 3, s52
    s_mov_b32 exec_hi, 0
    ds_write_b64 v2, v[24:25] offset:0
    ds_write_b64 v2, v[26:27] offset:256
    ds_write_b64 v2, v[28:29] offset:512
    s_mov_b32 exec_hi, -1
    s_cmp_eq_u32 s45, 2
    s_cbranch_scc1 L_c3s_98
    s_cmp_eq_u32 s56, 1
    s_cbranch_scc1 L_sm_100
    buffer_store_dwordx4 v[240:243], v20, s[32:35], 0 offen offset:0 sc1
    buffer_store_dwordx4 v[244:247], v20, s[32:35], 0 offen offset:512 sc1
    buffer_store_dwordx4 v[248:251], v20, s[32:35], 0 offen offset:1024 sc1
    s_branch L_sm_101
L_sm_100:
    buffer_store_dwordx4 v[240:243], v20, s[32:35], 0 offen offset:0
    buffer_store_dwordx4 v[244:247], v20, s[32:35], 0 offen offset:512
    buffer_store_dwordx4 v[248:251], v20, s[32:35], 0 offen offset:1024
L_sm_101:
    s_branch L_c3t_99
L_c3s_98:
    s_cmp_eq_u32 s56, 1
    s_cbranch_scc1 L_sm_102
    buffer_store_dwordx4 v[240:243], v20, s[32:35], 0 offen offset:0 sc1
    buffer_store_dwordx4 v[244:247], v20, s[32:35], 0 offen offset:512 sc1
    s_branch L_sm_103
L_sm_102:
    buffer_store_dwordx4 v[240:243], v20, s[32:35], 0 offen offset:0
    buffer_store_dwordx4 v[244:247], v20, s[32:35], 0 offen offset:512
L_sm_103:
L_c3t_99:
    s_waitcnt lgkmcnt(0)
    s_barrier
    s_waitcnt vmcnt(0)
    s_barrier
    s_branch L_P4
L_P4:
    s_lshr_b32 s45, s41, 3
    s_and_b32 s46, s41, 7
    s_lshl_b32 s43, s40, 8
    s_lshl_b32 s52, s45, 6
    s_add_u32 s43, s43, s52
    s_mul_i32 s44, s46, 192
    s_cmp_lt_u32 s42, 4
    s_cbranch_scc1 L_C4
    s_cmp_eq_u32 s42, 6
    s_cbranch_scc1 L_S4
    s_cmp_eq_u32 s42, 7
    s_cbranch_scc1 L_X4
    s_lshr_b32 s45, s41, 3
    s_and_b32 s46, s41, 7
    s_lshl_b32 s43, s40, 8
    s_lshl_b32 s52, s45, 6
    s_add_u32 s43, s43, s52
    s_mul_i32 s44, s46, 192
    v_add_u32 v2, 0, v0
    v_mul_u32_u24 v3, 171, v2
    v_lshrrev_b32 v3, 12, v3
    v_mul_u32_u24 v4, 24, v3
    v_sub_u32 v4, v2, v4
    v_bfe_u32 v5, v3, 1, 1
    v_lshlrev_b32 v5, 2, v5
    v_xor_b32 v4, v4, v5
    v_and_b32 v5, 3, v3
    v_lshrrev_b32 v6, 2, v3
    v_lshl_add_u32 v5, v6, 3, v5
    v_mul_u32_u24 v5, 3072, v5
    v_lshl_add_u32 v8, v4, 4, v5
    v_add_u32 v2, 64, v0
    v_mul_u32_u24 v3, 171, v2
    v_lshrrev_b32 v3, 12, v3
    v_mul_u32_u24 v4, 24, v3
    v_sub_u32 v4, v2, v4
    v_bfe_u32 v5, v3, 1, 1
    v_lshlrev_b32 v5, 2, v5
    v_xor_b32 v4, v4, v5
    v_and_b32 v5, 3, v3
    v_lshrrev_b32 v6, 2, v3
    v_lshl_add_u32 v5, v6, 3, v5
    v_mul_u32_u24 v5, 3072, v5
    v_lshl_add_u32 v9, v4, 4, v5
    v_add_u32 v2, 128, v0
    v_mul_u32_u24 v3, 171, v2
    v_lshrrev_b32 v3, 12, v3
    v_mul_u32_u24 v4, 24, v3
    v_sub_u32 v4, v2, v4
    v_bfe_u32 v5, v3, 1, 1
    v_lshlrev_b32 v5, 2, v5
    v_xor_b32 v4, v4, v5
    v_and_b32 v5, 3, v3
    v_lshrrev_b32 v6, 2, v3
    v_lshl_add_u32 v5, v6, 3, v5
    v_mul_u32_u24 v5, 3072, v5
    v_lshl_add_u32 v10, v4, 4, v5
    v_add_u32 v11, 12288, v8
    v_add_u32 v12, 12288, v9
    v_add_u32 v13, 12288, v10
    v_add_u32 v14, 49152, v8
    v_add_u32 v15, 49152, v9
    v_add_u32 v16, 49152, v10
    v_add_u32 v17, 61440, v8
    v_add_u32 v18, 61440, v9
    v_add_u32 v19, 61440, v10
    v_lshrrev_b32 v2, 5, v0
    v_and_b32 v3, 31, v0
    v_lshlrev_b32 v2, 15, v2
    v_lshl_add_u32 v20, v3, 4, v2
    v_add_u32 v21, 512, v20
    v_add_u32 v22, 65536, v20
    v_add_u32 v23, 66048, v20
    s_and_b32 s51, s42, 1
    s_lshl_b32 s52, s44, 1
    s_add_u32 s28, s12, s52
    s_addc_u32 s29, s13, 0
    s_sub_u32 s30, 1966080, s52
    s_mov_b32 s31, 0x20000
    s_mul_i32 s48, s51, 98304
    s_lshl_b32 s47, s43, 4
    s_add_u32 s47, s47, 3670016
    s_mul_i32 s52, s51, 131072
    s_add_u32 s47, s47, s52
    s_mul_i32 s54, s51, 12288
    s_lshl_b32 s63, s51, 12
    s_add_u32 s63, s63, 24576
    s_add_u32 s52, s54, 0
    s_add_u32 m0, s52, 0
    s_nop 0
    buffer_load_dwordx4 v8, s[28:31], s48 offen lds
    s_add_u32 m0, m0, s62
    s_nop 0
    buffer_load_dwordx4 v9, s[28:31], s48 offen lds
    s_add_u32 m0, m0, s62
    s_nop 0
    buffer_load_dwordx4 v10, s[28:31], s48 offen lds
    s_add_u32 m0, m0, s62
    s_nop 0
    buffer_load_dwordx4 v11, s[28:31], s48 offen lds
    s_add_u32 m0, m0, s62
    s_nop 0
    buffer_load_dwordx4 v12, s[28:31], s48 offen lds
    s_add_u32 m0, m0, s62
    s_nop 0
    buffer_load_dwordx4 v13, s[28:31], s48 offen lds
    s_add_u32 m0, m0, s62
    s_nop 0
    buffer_load_dwordx4 v14, s[28:31], s48 offen lds
    s_add_u32 m0, m0, s62
    s_nop 0
    buffer_load_dwordx4 v15, s[28:31], s48 offen lds
    s_add_u32 m0, m0, s62
    s_nop 0
    buffer_load_dwordx4 v16, s[28:31], s48 offen lds
    s_add_u32 m0, m0, s62
    s_nop 0
    buffer_load_dwordx4 v17, s[28:31], s48 offen lds
    s_add_u32 m0, m0, s62
    s_nop 0
    buffer_load_dwordx4 v18, s[28:31], s48 offen lds
    s_add_u32 m0, m0, s62
    s_nop 0
    buffer_load_dwordx4 v19, s[28:31], s48 offen lds
    s_add_u32 s48, s48, 196608
    s_add_u32 s52, s54, 32768
    s_add_u32 m0, s52, 0
    s_nop 0
    buffer_load_dwordx4 v8, s[28:31], s48 offen lds
    s_add_u32 m0, m0, s62
    s_nop 0
    buffer_load_dwordx4 v9, s[28:31], s48 offen lds
    s_add_u32 m0, m0, s62
    s_nop 0
    buffer_load_dwordx4 v10, s[28:31], s48 offen lds
    s_add_u32 m0, m0, s62
    s_nop 0
    buffer_load_dwordx4 v11, s[28:31], s48 offen lds
    s_add_u32 m0, m0, s62
    s_nop 0
    buffer_load_dwordx4 v12, s[28:31], s48 offen lds
    s_add_u32 m0, m0, s62
    s_nop 0
    buffer_load_dwordx4 v13, s[28:31], s48 offen lds
    s_add_u32 m0, m0, s62
    s_nop 0
    buffer_load_dwordx4 v14, s[28:31], s48 offen lds
    s_add_u32 m0, m0, s62
    s_nop 0
    buffer_load_dwordx4 v15, s[28:31], s48 offen lds
    s_add_u32 m0, m0, s62
    s_nop 0
    buffer_load_dwordx4 v16, s[28:31], s48 offen lds
    s_add_u32 m0, m0, s62
    s_nop 0
    buffer_load_dwordx4 v17, s[28:31], s48 offen lds
    s_add_u32 m0, m0, s62
    s_nop 0
    buffer_load_dwordx4 v18, s[28:31], s48 offen lds
    s_add_u32 m0, m0, s62
    s_nop 0
    buffer_load_dwordx4 v19, s[28:31], s48 offen lds
    s_add_u32 s48, s48, 196608
    s_add_u32 s52, s54, 65536
    s_add_u32 m0, s52, 0
    s_nop 0
    buffer_load_dwordx4 v8, s[28:31], s48 offen lds
    s_add_u32 m0, m0, s62
    s_nop 0
    buffer_load_dwordx4 v9, s[28:31], s48 offen lds
    s_add_u32 m0, m0, s62
    s_nop 0
    buffer_load_dwordx4 v10, s[28:31], s48 offen lds
    s_add_u32 m0, m0, s62
    s_nop 0
    buffer_load_dwordx4 v11, s[28:31], s48 offen lds
    s_add_u32 m0, m0, s62
    s_nop 0
    buffer_load_dwordx4 v12, s[28:31], s48 offen lds
    s_add_u32 m0, m0, s62
    s_nop 0
    buffer_load_dwordx4 v13, s[28:31], s48 offen lds
    s_add_u32 m0, m0, s62
    s_nop 0
    buffer_load_dwordx4 v14, s[28:31], s48 offen lds
    s_add_u32 m0, m0, s62
    s_nop 0
    buffer_load_dwordx4 v15, s[28:31], s48 offen lds
    s_add_u32 m0, m0, s62
    s_nop 0
    buffer_load_dwordx4 v16, s[28:31], s48 offen lds
    s_add_u32 m0, m0, s62
    s_nop 0
    buffer_load_dwordx4 v17, s[28:31], s48 offen lds
    s_add_u32 m0, m0, s62
    s_nop 0
    buffer_load_dwordx4 v18, s[28:31], s48 offen lds
    s_add_u32 m0, m0, s62
    s_nop 0
    buffer_load_dwordx4 v19, s[28:31], s48 offen lds
    s_add_u32 s48, s48, 196608
    s_add_u32 s52, s54, 98304
    s_add_u32 m0, s52, 0
    s_nop 0
    buffer_load_dwordx4 v8, s[28:31], s48 offen lds
    s_add_u32 m0, m0, s62
    s_nop 0
    buffer_load_dwordx4 v9, s[28:31], s48 offen lds
    s_add_u32 m0, m0, s62
    s_nop 0
    buffer_load_dwordx4 v10, s[28:31], s48 offen lds
    s_add_u32 m0, m0, s62
    s_nop 0
    buffer_load_dwordx4 v11, s[28:31], s48 offen lds
    s_add_u32 m0, m0, s62
    s_nop 0
    buffer_load_dwordx4 v12, s[28:31], s48 offen lds
    s_add_u32 m0, m0, s62
    s_nop 0
    buffer_load_dwordx4 v13, s[28:31], s48 offen lds
    s_add_u32 m0, m0, s62
    s_nop 0
    buffer_load_dwordx4 v14, s[28:31], s48 offen lds
    s_add_u32 m0, m0, s62
    s_nop 0
    buffer_load_dwordx4 v15, s[28:31], s48 offen lds
    s_add_u32 m0, m0, s62
    s_nop 0
    buffer_load_dwordx4 v16, s[28:31], s48 offen lds
    s_add_u32 m0, m0, s62
    s_nop 0
    buffer_load_dwordx4 v17, s[28:31], s48 offen lds
    s_add_u32 m0, m0, s62
    s_nop 0
    buffer_load_dwordx4 v18, s[28:31], s48 offen lds
    s_add_u32 m0, m0, s62
    s_nop 0
    buffer_load_dwordx4 v19, s[28:31], s48 offen lds
    s_add_u32 s48, s48, 196608
L_L4B:
    s_barrier
    s_add_u32 s52, s63, 0
    s_add_u32 m0, s52, 0
    s_nop 0
    buffer_load_dwordx4 v20, s[32:35], s47 offen sc1 lds
    s_add_u32 m0, m0, s62
    s_nop 0
    buffer_load_dwordx4 v21, s[32:35], s47 offen sc1 lds
    s_add_u32 m0, m0, s62
    s_nop 0
    buffer_load_dwordx4 v22, s[32:35], s47 offen sc1 lds
    s_add_u32 m0, m0, s62
    s_nop 0
    buffer_load_dwordx4 v23, s[32:35], s47 offen sc1 lds
    s_add_u32 s47, s47, 262144
    s_add_u32 s52, s63, 32768
    s_add_u32 m0, s52, 0
    s_nop 0
    buffer_load_dwordx4 v20, s[32:35], s47 offen sc1 lds
    s_add_u32 m0, m0, s62
    s_nop 0
    buffer_load_dwordx4 v21, s[32:35], s47 offen sc1 lds
    s_add_u32 m0, m0, s62
    s_nop 0
    buffer_load_dwordx4 v22, s[32:35], s47 offen sc1 lds
    s_add_u32 m0, m0, s62
    s_nop 0
    buffer_load_dwordx4 v23, s[32:35], s47 offen sc1 lds
    s_add_u32 s47, s47, 262144
    s_waitcnt vmcnt(4)
    s_barrier
    s_add_u32 s52, s63, 65536
    s_add_u32 m0, s52, 0
    s_nop 0
    buffer_load_dwordx4 v20, s[32:35], s47 offen sc1 lds
    s_add_u32 m0, m0, s62
    s_nop 0
    buffer_load_dwordx4 v21, s[32:35], s47 offen sc1 lds
    s_add_u32 m0, m0, s62
    s_nop 0
    buffer_load_dwordx4 v22, s[32:35], s47 offen sc1 lds
    s_add_u32 m0, m0, s62
    s_nop 0
    buffer_load_dwordx4 v23, s[32:35], s47 offen sc1 lds
    s_add_u32 s47, s47, 262144
    s_add_u32 s52, s63, 98304
    s_add_u32 m0, s52, 0
    s_nop 0
    buffer_load_dwordx4 v20, s[32:35], s47 offen sc1 lds
    s_add_u32 m0, m0, s62
    s_nop 0
    buffer_load_dwordx4 v21, s[32:35], s47 offen sc1 lds
    s_add_u32 m0, m0, s62
    s_nop 0
    buffer_load_dwordx4 v22, s[32:35], s47 offen sc1 lds
    s_add_u32 m0, m0, s62
    s_nop 0
    buffer_load_dwordx4 v23, s[32:35], s47 offen sc1 lds
    s_add_u32 s47, s47, 262144
    s_mov_b32 s51, 0
    s_mov_b32 s50, 0
L_L4LOOP:
    s_cmp_eq_u32 s51, 0
    s_cbranch_scc1 L_rw_104
    s_cmp_eq_u32 s51, 1
    s_cbranch_scc1 L_rw_105
    s_cmp_eq_u32 s51, 7
    s_cbranch_scc1 L_rw_106
    s_cmp_gt_u32 s51, 7
    s_cbranch_scc1 L_rw_107
    s_waitcnt vmcnt(32)
    s_branch L_t_109
L_rw_104:
    s_waitcnt vmcnt(8)
    s_branch L_t_109
L_rw_105:
    s_waitcnt vmcnt(20)
    s_branch L_t_109
L_rw_106:
    s_waitcnt vmcnt(16)
    s_branch L_t_109
L_rw_107:
    s_waitcnt vmcnt(0)
L_t_109:
    s_barrier
    s_cmp_gt_u32 s51, 5
    s_cbranch_scc1 L_s_110
    s_add_u32 s52, s63, s50
    s_add_u32 m0, s52, 0
    s_nop 0
    buffer_load_dwordx4 v20, s[32:35], s47 offen sc1 lds
    s_add_u32 m0, m0, s62
    s_nop 0
    buffer_load_dwordx4 v21, s[32:35], s47 offen sc1 lds
    s_add_u32 m0, m0, s62
    s_nop 0
    buffer_load_dwordx4 v22, s[32:35], s47 offen sc1 lds
    s_add_u32 m0, m0, s62
    s_nop 0
    buffer_load_dwordx4 v23, s[32:35], s47 offen sc1 lds
    s_add_u32 s52, s54, s50
    s_add_u32 m0, s52, 0
    s_nop 0
    buffer_load_dwordx4 v8, s[28:31], s48 offen lds
    s_add_u32 m0, m0, s62
    s_nop 0
    buffer_load_dwordx4 v9, s[28:31], s48 offen lds
    s_add_u32 m0, m0, s62
    s_nop 0
    buffer_load_dwordx4 v10, s[28:31], s48 offen lds
    s_add_u32 m0, m0, s62
    s_nop 0
    buffer_load_dwordx4 v11, s[28:31], s48 offen lds
    s_add_u32 m0, m0, s62
    s_nop 0
    buffer_load_dwordx4 v12, s[28:31], s48 offen lds
    s_add_u32 m0, m0, s62
    s_nop 0
    buffer_load_dwordx4 v13, s[28:31], s48 offen lds
    s_add_u32 m0, m0, s62
    s_nop 0
    buffer_load_dwordx4 v14, s[28:31], s48 offen lds
    s_add_u32 m0, m0, s62
    s_nop 0
    buffer_load_dwordx4 v15, s[28:31], s48 offen lds
    s_add_u32 m0, m0, s62
    s_nop 0
    buffer_load_dwordx4 v16, s[28:31], s48 offen lds
    s_add_u32 m0, m0, s62
    s_nop 0
    buffer_load_dwordx4 v17, s[28:31], s48 offen lds
    s_add_u32 m0, m0, s62
    s_nop 0
    buffer_load_dwordx4 v18, s[28:31], s48 offen lds
    s_add_u32 m0, m0, s62
    s_nop 0
    buffer_load_dwordx4 v19, s[28:31], s48 offen lds
    s_add_u32 s47, s47, 262144
    s_add_u32 s48, s48, 196608
L_s_110:
    s_add_u32 s50, s50, 32768
    s_cmp_eq_u32 s50, 131072
    s_cselect_b32 s50, 0, s50
    s_add_u32 s51, s51, 1
    s_cmp_lt_u32 s51, 10
    s_cbranch_scc1 L_L4LOOP
    s_cmp_ge_u32 s41, 30
    s_cbranch_scc1 L_no5_111
    s_mul_i32 s45, s41, 26
    s_lshr_b32 s45, s45, 8
    s_mul_i32 s52, s45, 10
    s_sub_u32 s46, s41, s52
    s_mul_i32 s52, s45, 96
    s_lshl_b32 s43, s40, 8
    s_add_u32 s43, s43, s52
    v_lshrrev_b32 v2, 3, v0
    v_and_b32 v3, 7, v0
    v_bfe_u32 v4, v0, 4, 1
    v_lshlrev_b32 v4, 2, v4
    v_xor_b32 v3, v3, v4
    v_and_b32 v4, 3, v2
    v_lshrrev_b32 v5, 2, v2
    v_lshl_add_u32 v6, v5, 3, v4
    v_mul_u32_u24 v6, 1280, v6
    v_lshl_add_u32 v8, v3, 4, v6
    v_add_u32 v9, 5120, v8
    v_add_u32 v10, 20480, v8
    v_add_u32 v11, 25600, v8
    v_add_u32 v12, 40960, v8
    v_add_u32 v13, 46080, v8
    v_add_u32 v14, 61440, v8
    v_add_u32 v15, 66560, v8
    v_lshrrev_b32 v2, 5, v0
    v_and_b32 v3, 31, v0
    v_lshlrev_b32 v2, 15, v2
    v_lshl_add_u32 v20, v3, 4, v2
    v_add_u32 v21, 512, v20
    v_add_u32 v22, 1024, v20
    v_add_u32 v23, 65536, v20
    v_add_u32 v24, 66048, v20
    v_add_u32 v25, 66560, v20
    v_add_u32 v26, 131072, v20
    v_add_u32 v27, 131584, v20
    v_add_u32 v28, 132096, v20
    v_add_u32 v29, 196608, v20
    v_add_u32 v30, 197120, v20
    v_add_u32 v31, 197632, v20
    s_and_b32 s51, s42, 1
    s_lshl_b32 s52, s46, 7
    s_add_u32 s28, s14, s52
    s_addc_u32 s29, s15, 0
    s_sub_u32 s30, 1966080, s52
    s_mov_b32 s31, 0x20000
    s_mul_i32 s48, s51, 81920
    s_lshl_b32 s47, s43, 4
    s_add_u32 s47, s47, 1048576
    s_mul_i32 s52, s51, 262144
    s_add_u32 s47, s47, s52
    s_lshl_b32 s54, s51, 13
    s_mul_i32 s63, s51, 12288
    s_add_u32 s63, s63, 16384
    s_add_u32 s52, s54, 0
    s_add_u32 m0, s52, 0
    s_nop 0
    buffer_load_dwordx4 v8, s[28:31], s48 offen lds
    s_add_u32 m0, m0, s62
    s_nop 0
    buffer_load_dwordx4 v9, s[28:31], s48 offen lds
    s_add_u32 m0, m0, s62
    s_nop 0
    buffer_load_dwordx4 v10, s[28:31], s48 offen lds
    s_add_u32 m0, m0, s62
    s_nop 0
    buffer_load_dwordx4 v11, s[28:31], s48 offen lds
    s_add_u32 m0, m0, s62
    s_nop 0
    buffer_load_dwordx4 v12, s[28:31], s48 offen lds
    s_add_u32 m0, m0, s62
    s_nop 0
    buffer_load_dwordx4 v13, s[28:31], s48 offen lds
    s_add_u32 m0, m0, s62
    s_nop 0
    buffer_load_dwordx4 v14, s[28:31], s48 offen lds
    s_add_u32 m0, m0, s62
    s_nop 0
    buffer_load_dwordx4 v15, s[28:31], s48 offen lds
    s_add_u32 s48, s48, 163840
    s_add_u32 s52, s54, 40960
    s_add_u32 m0, s52, 0
    s_nop 0
    buffer_load_dwordx4 v8, s[28:31], s48 offen lds
    s_add_u32 m0, m0, s62
    s_nop 0
    buffer_load_dwordx4 v9, s[28:31], s48 offen lds
    s_add_u32 m0, m0, s62
    s_nop 0
    buffer_load_dwordx4 v10, s[28:31], s48 offen lds
    s_add_u32 m0, m0, s62
    s_nop 0
    buffer_load_dwordx4 v11, s[28:31], s48 offen lds
    s_add_u32 m0, m0, s62
    s_nop 0
    buffer_load_dwordx4 v12, s[28:31], s48 offen lds
    s_add_u32 m0, m0, s62
    s_nop 0
    buffer_load_dwordx4 v13, s[28:31], s48 offen lds
    s_add_u32 m0, m0, s62
    s_nop 0
    buffer_load_dwordx4 v14, s[28:31], s48 offen lds
    s_add_u32 m0, m0, s62
    s_nop 0
    buffer_load_dwordx4 v15, s[28:31], s48 offen lds
    s_add_u32 s48, s48, 163840
    s_add_u32 s52, s54, 81920
    s_add_u32 m0, s52, 0
    s_nop 0
    buffer_load_dwordx4 v8, s[28:31], s48 offen lds
    s_add_u32 m0, m0, s62
    s_nop 0
    buffer_load_dwordx4 v9, s[28:31], s48 offen lds
    s_add_u32 m0, m0, s62
    s_nop 0
    buffer_load_dwordx4 v10, s[28:31], s48 offen lds
    s_add_u32 m0, m0, s62
    s_nop 0
    buffer_load_dwordx4 v11, s[28:31], s48 offen lds
    s_add_u32 m0, m0, s62
    s_nop 0
    buffer_load_dwordx4 v12, s[28:31], s48 offen lds
    s_add_u32 m0, m0, s62
    s_nop 0
    buffer_load_dwordx4 v13, s[28:31], s48 offen lds
    s_add_u32 m0, m0, s62
    s_nop 0
    buffer_load_dwordx4 v14, s[28:31], s48 offen lds
    s_add_u32 m0, m0, s62
    s_nop 0
    buffer_load_dwordx4 v15, s[28:31], s48 offen lds
    s_add_u32 s48, s48, 163840
    s_add_u32 s52, s54, 122880
    s_add_u32 m0, s52, 0
    s_nop 0
    buffer_load_dwordx4 v8, s[28:31], s48 offen lds
    s_add_u32 m0, m0, s62
    s_nop 0
    buffer_load_dwordx4 v9, s[28:31], s48 offen lds
    s_add_u32 m0, m0, s62
    s_nop 0
    buffer_load_dwordx4 v10, s[28:31], s48 offen lds
    s_add_u32 m0, m0, s62
    s_nop 0
    buffer_load_dwordx4 v11, s[28:31], s48 offen lds
    s_add_u32 m0, m0, s62
    s_nop 0
    buffer_load_dwordx4 v12, s[28:31], s48 offen lds
    s_add_u32 m0, m0, s62
    s_nop 0
    buffer_load_dwordx4 v13, s[28:31], s48 offen lds
    s_add_u32 m0, m0, s62
    s_nop 0
    buffer_load_dwordx4 v14, s[28:31], s48 offen lds
    s_add_u32 m0, m0, s62
    s_nop 0
    buffer_load_dwordx4 v15, s[28:31], s48 offen lds
    s_add_u32 s48, s48, 163840
    s_barrier
    s_branch L_L5B
L_no5_111:
    s_barrier
    s_branch L_FIN
L_S4:
    s_mov_b32 s63, 0x3ff
    s_cmp_eq_u32 s45, 1
    s_cselect_b32 s63, 0xfffff, s63
    s_cmp_eq_u32 s45, 2
    s_cselect_b32 s63, 0xffc00, s63
    s_cmp_eq_u32 s45, 3
    s_cselect_b32 s63, 0x3ff00000, s63
    v_and_b32 v2, 1, v0
    v_add_u32 v2, 30, v2
    v_lshlrev_b32 v2, 3, v2
    v_lshrrev_b32 v3, 1, v0
    v_or_b32 v2, v2, v3
    v_lshlrev_b32 v2, 7, v2
    v_cmp_gt_u32 vcc, 12, v0
    s_nop 1
    v_cndmask_b32 v8, 0, v2, vcc
    v_cndmask_b32 v9, 0, 2, vcc
L_poll_112:
    buffer_load_dword v10, v8, s[32:35], 0 offen sc1
L_poll_113:
    s_waitcnt vmcnt(0)
    v_cmp_lt_u32 s[60:61], v10, v9
    s_nop 2
    s_cmp_eq_u64 s[60:61], 0
    s_cbranch_scc0 L_poll_112
    s_cmp_lt_u32 s41, 30
    s_cbranch_scc1 L_kq_114
    s_lshl_b32 s52, s40, 5
    s_load_dwordx8 s[64:71], s[18:19], s52
    s_add_u32 s52, s40, 1
    s_min_u32 s52, s52, 7
    s_lshl_b32 s52, s52, 5
    s_load_dwordx8 s[72:79], s[18:19], s52
    s_branch L_kf_116
L_kf_115:
    s_sleep 8
    s_lshl_b32 s52, s40, 5
    s_load_dwordx8 s[64:71], s[18:19], s52 glc
    s_add_u32 s52, s40, 1
    s_min_u32 s52, s52, 7
    s_lshl_b32 s52, s52, 5
    s_load_dwordx8 s[72:79], s[18:19], s52 glc
L_kf_116:
    s_waitcnt lgkmcnt(0)
    s_mov_b32 s52, 0x40404040
    s_and_b32 s52, s52, s64
    s_and_b32 s52, s52, s65
    s_and_b32 s52, s52, s66
    s_and_b32 s52, s52, s67
    s_and_b32 s52, s52, s68
    s_and_b32 s52, s52, s69
    s_and_b32 s52, s52, s70
    s_and_b32 s52, s52, s71
    s_and_b32 s52, s52, s72
    s_and_b32 s52, s52, s73
    s_and_b32 s52, s52, s74
    s_and_b32 s52, s52, s75
    s_and_b32 s52, s52, s76
    s_and_b32 s52, s52, s77
    s_and_b32 s52, s52, s78
    s_and_b32 s52, s52, s79
    s_cmp_eq_u32 s52, 0x40404040
    s_cbranch_scc0 L_kf_115
L_kq_114:
    s_lshl_b32 s53, s40, 8
    s_add_u32 s53, s53, 32768
    v_and_b32 v2, 31, v0
    v_lshl_add_u32 v8, v2, 2, s53
    v_mov_b32 v3, s63
    v_lshrrev_b32 v3, v2, v3
    v_and_b32 v3, 1, v3
    v_mul_u32_u24 v9, 4, v3
L_poll_117:
    buffer_load_dword v10, v8, s[32:35], 0 offen sc1
L_poll_118:
    s_waitcnt vmcnt(0)
    v_cmp_lt_u32 s[60:61], v10, v9
    s_nop 2
    s_cmp_eq_u64 s[60:61], 0
    s_cbranch_scc0 L_poll_117
    s_barrier
    s_barrier
    s_mov_b32 s51, 0
L_S4LOOP:
    s_barrier
    s_add_u32 s51, s51, 1
    s_cmp_lt_u32 s51, 10
    s_cbranch_scc1 L_S4LOOP
    s_barrier
    s_lshl_b32 s52, s40, 8
    s_lshl_b32 s53, s41, 2
    s_add_u32 s52, s52, s53
    s_add_u32 s52, s52, 32768
    v_mov_b32 v2, 5
    v_mov_b32 v3, 0
    s_mov_b64 exec, 1
    s_cmp_eq_u32 s56, 1
    s_cbranch_scc1 L_sm_119
    buffer_store_dword v2, v3, s[32:35], s52 offen sc1
    s_branch L_sm_120
L_sm_119:
    buffer_store_dword v2, v3, s[32:35], s52 offen
L_sm_120:
    s_mov_b64 exec, -1
    s_branch L_P5
L_X4:
    s_barrier
    s_lshl_b32 s52, s43, 3
    s_add_u32 s52, s52, 131072
    v_lshlrev_b32 v2, 3, v0
    buffer_load_dwordx2 v[8:9], v2, s[32:35], s52 offen sc1
    s_add_u32 s52, s52, 16384
    buffer_load_dwordx2 v[10:11], v2, s[32:35], s52 offen sc1
    s_add_u32 s52, s52, 16384
    buffer_load_dwordx2 v[12:13], v2, s[32:35], s52 offen sc1
    s_add_u32 s52, s52, 16384
    buffer_load_dwordx2 v[14:15], v2, s[32:35], s52 offen sc1
    s_add_u32 s52, s52, 16384
    buffer_load_dwordx2 v[16:17], v2, s[32:35], s52 offen sc1
    s_add_u32 s52, s52, 16384
    buffer_load_dwordx2 v[18:19], v2, s[32:35], s52 offen sc1
    s_add_u32 s52, s52, 16384
    buffer_load_dwordx2 v[20:21], v2, s[32:35], s52 offen sc1
    s_add_u32 s52, s52, 16384
    buffer_load_dwordx2 v[22:23], v2, s[32:35], s52 offen sc1
    s_add_u32 s52, s52, 16384
    buffer_load_dwordx2 v[24:25], v2, s[32:35], s52 offen sc1
    s_add_u32 s52, s52, 16384
    buffer_load_dwordx2 v[26:27], v2, s[32:35], s52 offen sc1
    s_add_u32 s52, s52, 16384
    s_lshl_b32 s52, s44, 2
    s_add_u32 s52, s52, 90112
    v_lshlrev_b32 v3, 4, v0
    s_mov_b32 m0, 162304
    s_mov_b32 exec_hi, 0xffff
    buffer_load_dwordx4 v3, s[32:35], s52 offen sc1 lds
    s_mov_b32 exec_hi, -1
    s_barrier
    s_waitcnt vmcnt(0)
    v_add_f32 v8, v8, v10
    v_add_f32 v9, v9, v11
    v_add_f32 v8, v8, v12
    v_add_f32 v9, v9, v13
    v_add_f32 v8, v8, v14
    v_add_f32 v9, v9, v15
    v_add_f32 v8, v8, v16
    v_add_f32 v9, v9, v17
    v_add_f32 v8, v8, v18
    v_add_f32 v9, v9, v19
    v_add_f32 v8, v8, v20
    v_add_f32 v9, v9, v21
    v_add_f32 v8, v8, v22
    v_add_f32 v9, v9, v23
    v_add_f32 v8, v8, v24
    v_add_f32 v9, v9, v25
    v_add_f32 v8, v8, v26
    v_add_f32 v9, v9, v27
    v_mul_f32 v8, 0x3acccccd, v8
    v_mul_f32 v9, 0x3acccccd, v9
    v_fma_f32 v9, -v8, v8, v9
    v_max_f32 v9, 0, v9
    v_add_f32 v9, 0x3727c5ac, v9
    v_rsq_f32 v10, v9
    v_mul_f32 v11, -1.0, v8
    v_mul_f32 v11, v11, v10
    v_add_u32 v2, 161792, v2
    ds_write_b64 v2, v[10:11]
    s_waitcnt lgkmcnt(0)
    s_mov_b32 s51, 0
L_X4LOOP:
    s_barrier
    s_add_u32 s51, s51, 1
    s_cmp_lt_u32 s51, 10
    s_cbranch_scc1 L_X4LOOP
    s_barrier
    s_branch L_P5
L_C4:
    v_lshrrev_b32 v2, 5, v0
    v_bfe_u32 v3, v0, 2, 2
    v_lshl_add_u32 v6, v2, 3, v3
    v_mul_u32_u24 v6, 384, v6
    v_and_b32 v5, 1, v0
    v_lshl_add_u32 v6, v5, 3, v6
    v_bfe_u32 v4, v0, 4, 1
    v_lshlrev_b32 v4, 1, v4
    v_bfe_u32 v5, v0, 1, 1
    v_or_b32 v4, v4, v5
    s_and_b32 s52, s42, 1
    s_mul_i32 s52, s52, 12
    v_add_u32 v4, s52, v4
    v_bfe_u32 v5, v0, 3, 1
    v_lshlrev_b32 v5, 2, v5
    v_add_u32 v7, 0, v4
    v_xor_b32 v7, v7, v5
    v_lshl_add_u32 v8, v7, 4, v6
    v_add_u32 v7, 4, v4
    v_xor_b32 v7, v7, v5
    v_lshl_add_u32 v9, v7, 4, v6
    v_add_u32 v7, 8, v4
    v_xor_b32 v7, v7, v5
    v_lshl_add_u32 v10, v7, 4, v6
    s_lshr_b32 s52, s42, 1
    s_lshl_b32 s52, s52, 10
    s_add_u32 s52, s52, 24576
    v_lshl_add_u32 v16, v0, 4, s52
    v_mov_b64 v[64:65], 0
    v_mov_b64 v[66:67], 0
    v_mov_b64 v[68:69], 0
    v_mov_b64 v[70:71], 0
    v_mov_b64 v[72:73], 0
    v_mov_b64 v[74:75], 0
    v_mov_b64 v[76:77], 0
    v_mov_b64 v[78:79], 0
    v_mov_b64 v[80:81], 0
    v_mov_b64 v[82:83], 0
    v_mov_b64 v[84:85], 0
    v_mov_b64 v[86:87], 0
    v_mov_b64 v[88:89], 0
    v_mov_b64 v[90:91], 0
    v_mov_b64 v[92:93], 0
    v_mov_b64 v[94:95], 0
    v_mov_b64 v[96:97], 0
    v_mov_b64 v[98:99], 0
    v_mov_b64 v[100:101], 0
    v_mov_b64 v[102:103], 0
    v_mov_b64 v[104:105], 0
    v_mov_b64 v[106:107], 0
    v_mov_b64 v[108:109], 0
    v_mov_b64 v[110:111], 0
    v_and_b32 v1, 31, v0
    s_lshr_b32 s52, s42, 1
    s_lshl_b32 s52, s52, 5
    v_add_u32 v3, s52, v1
    v_lshlrev_b32 v20, 3, v3
    v_add_u32 v20, 161792, v20
    v_add_u32 v3, s43, v3
    s_and_b32 s52, s42, 1
    s_mul_i32 s52, s52, 96
    s_lshl_b32 s53, s52, 2
    s_add_u32 s53, s53, 162304
    v_lshl_add_u32 v21, v2, 4, s53
    s_add_u32 s52, s52, s44
    s_lshr_b32 s52, s52, 3
    s_mov_b32 s47, s52
    v_mov_b32 v4, v2
    v_lshlrev_b32 v4, 15, v4
    v_lshl_add_u32 v4, v3, 4, v4
    v_add_u32 v22, 1048576, v4
    s_mov_b32 s49, 0
    s_mov_b32 s51, 0
    v_add_u32 v12, s49, v8
    v_add_u32 v13, s49, v9
    v_add_u32 v14, s49, v10
    v_add_u32 v17, s49, v16
    s_barrier
    s_barrier
    ds_read_b128 v[136:139], v17 offset:0
    ds_read_b64_tr_b16 v[112:113], v12 offset:0
    ds_read_b64_tr_b16 v[114:115], v12 offset:1536
    ds_read_b64_tr_b16 v[116:117], v13 offset:0
    ds_read_b64_tr_b16 v[118:119], v13 offset:1536
    ds_read_b64_tr_b16 v[120:121], v14 offset:0
    ds_read_b64_tr_b16 v[122:123], v14 offset:1536
L_C4LOOP:
    s_waitcnt lgkmcnt(0)
    v_mfma_f32_32x32x16_bf16 v[64:79], v[112:115], v[136:139], v[64:79]
    ds_read_b128 v[140:143], v17 offset:2048
    ds_read_b64_tr_b16 v[124:125], v12 offset:6144
    ds_read_b64_tr_b16 v[126:127], v12 offset:7680
    v_mfma_f32_32x32x16_bf16 v[80:95], v[116:119], v[136:139], v[80:95]
    ds_read_b64_tr_b16 v[128:129], v13 offset:6144
    ds_read_b64_tr_b16 v[130:131], v13 offset:7680
    ds_read_b64_tr_b16 v[132:133], v14 offset:6144
    ds_read_b64_tr_b16 v[134:135], v14 offset:7680
    v_mfma_f32_32x32x16_bf16 v[96:111], v[120:123], v[136:139], v[96:111]
    s_waitcnt lgkmcnt(0)
    v_mfma_f32_32x32x16_bf16 v[64:79], v[124:127], v[140:143], v[64:79]
    ds_read_b128 v[136:139], v17 offset:4096
    ds_read_b64_tr_b16 v[112:113], v12 offset:12288
    ds_read_b64_tr_b16 v[114:115], v12 offset:13824
    v_mfma_f32_32x32x16_bf16 v[80:95], v[128:131], v[140:143], v[80:95]
    ds_read_b64_tr_b16 v[116:117], v13 offset:12288
    ds_read_b64_tr_b16 v[118:119], v13 offset:13824
    ds_read_b64_tr_b16 v[120:121], v14 offset:12288
    ds_read_b64_tr_b16 v[122:123], v14 offset:13824
    v_mfma_f32_32x32x16_bf16 v[96:111], v[132:135], v[140:143], v[96:111]
    s_waitcnt lgkmcnt(0)
    v_mfma_f32_32x32x16_bf16 v[64:79], v[112:115], v[136:139], v[64:79]
    ds_read_b128 v[140:143], v17 offset:6144
    ds_read_b64_tr_b16 v[124:125], v12 offset:18432
    ds_read_b64_tr_b16 v[126:127], v12 offset:19968
    v_mfma_f32_32x32x16_bf16 v[80:95], v[116:119], v[136:139], v[80:95]
    ds_read_b64_tr_b16 v[128:129], v13 offset:18432
    ds_read_b64_tr_b16 v[130:131], v13 offset:19968
    ds_read_b64_tr_b16 v[132:133], v14 offset:18432
    ds_read_b64_tr_b16 v[134:135], v14 offset:19968
    s_add_u32 s49, s49, 32768
    s_and_b32 s49, s49, 131071
    v_mfma_f32_32x32x16_bf16 v[96:111], v[120:123], v[136:139], v[96:111]
    v_add_u32 v12, s49, v8
    v_add_u32 v13, s49, v9
    v_add_u32 v14, s49, v10
    v_add_u32 v17, s49, v16
    s_waitcnt lgkmcnt(0)
    s_barrier
    v_mfma_f32_32x32x16_bf16 v[64:79], v[124:127], v[140:143], v[64:79]
    ds_read_b128 v[136:139], v17 offset:0
    ds_read_b64_tr_b16 v[112:113], v12 offset:0
    ds_read_b64_tr_b16 v[114:115], v12 offset:1536
    v_mfma_f32_32x32x16_bf16 v[80:95], v[128:131], v[140:143], v[80:95]
    ds_read_b64_tr_b16 v[116:117], v13 offset:0
    ds_read_b64_tr_b16 v[118:119], v13 offset:1536
    ds_read_b64_tr_b16 v[120:121], v14 offset:0
    ds_read_b64_tr_b16 v[122:123], v14 offset:1536
    v_mfma_f32_32x32x16_bf16 v[96:111], v[132:135], v[140:143], v[96:111]
    s_add_u32 s51, s51, 1
    s_cmp_lt_u32 s51, 10
    s_cbranch_scc1 L_C4LOOP
    s_waitcnt lgkmcnt(0)
    ds_read_b64 v[24:25], v20
    ds_read_b128 v[144:147], v21 offset:0
    ds_read_b128 v[148:151], v21 offset:32
    ds_read_b128 v[152:155], v21 offset:64
    ds_read_b128 v[156:159], v21 offset:96
    ds_read_b128 v[160:163], v21 offset:128
    ds_read_b128 v[164:167], v21 offset:160
    ds_read_b128 v[168:171], v21 offset:192
    ds_read_b128 v[172:175], v21 offset:224
    ds_read_b128 v[176:179], v21 offset:256
    ds_read_b128 v[180:183], v21 offset:288
    ds_read_b128 v[184:187], v21 offset:320
    ds_read_b128 v[188:191], v21 offset:352
    s_waitcnt lgkmcnt(0)
    v_mul_f32 v26, 0xbfb8aa3b, v24
    v_mul_f32 v27, 0xbfb8aa3b, v25
    v_mov_b32 v28, 1.0
    v_mov_b32 v29, 1.0
    v_pk_mul_f32 v[64:65], v[64:65], v[24:25] op_sel_hi:[1,0]
    v_pk_mul_f32 v[66:67], v[66:67], v[24:25] op_sel_hi:[1,0]
    v_pk_mul_f32 v[68:69], v[68:69], v[24:25] op_sel_hi:[1,0]
    v_pk_mul_f32 v[70:71], v[70:71], v[24:25] op_sel_hi:[1,0]
    v_pk_mul_f32 v[72:73], v[72:73], v[24:25] op_sel_hi:[1,0]
    v_pk_mul_f32 v[74:75], v[74:75], v[24:25] op_sel_hi:[1,0]
    v_pk_mul_f32 v[76:77], v[76:77], v[24:25] op_sel_hi:[1,0]
    v_pk_mul_f32 v[78:79], v[78:79], v[24:25] op_sel_hi:[1,0]
    v_pk_fma_f32 v[64:65], v[144:145], v[24:25], v[64:65] op_sel:[0,1,0] op_sel_hi:[1,1,1]
    v_pk_fma_f32 v[66:67], v[146:147], v[24:25], v[66:67] op_sel:[0,1,0] op_sel_hi:[1,1,1]
    v_pk_fma_f32 v[68:69], v[148:149], v[24:25], v[68:69] op_sel:[0,1,0] op_sel_hi:[1,1,1]
    v_pk_fma_f32 v[70:71], v[150:151], v[24:25], v[70:71] op_sel:[0,1,0] op_sel_hi:[1,1,1]
    v_pk_fma_f32 v[72:73], v[152:153], v[24:25], v[72:73] op_sel:[0,1,0] op_sel_hi:[1,1,1]
    v_pk_fma_f32 v[74:75], v[154:155], v[24:25], v[74:75] op_sel:[0,1,0] op_sel_hi:[1,1,1]
    v_pk_fma_f32 v[76:77], v[156:157], v[24:25], v[76:77] op_sel:[0,1,0] op_sel_hi:[1,1,1]
    v_pk_fma_f32 v[78:79], v[158:159], v[24:25], v[78:79] op_sel:[0,1,0] op_sel_hi:[1,1,1]
    v_mul_f32 v144, 0xbfb8aa3b, v64
    v_mul_f32 v145, 0xbfb8aa3b, v65
    v_mul_f32 v146, 0xbfb8aa3b, v66
    v_mul_f32 v147, 0xbfb8aa3b, v67
    v_mul_f32 v148, 0xbfb8aa3b, v68
    v_mul_f32 v149, 0xbfb8aa3b, v69
    v_mul_f32 v150, 0xbfb8aa3b, v70
    v_mul_f32 v151, 0xbfb8aa3b, v71
    v_mul_f32 v152, 0xbfb8aa3b, v72
    v_mul_f32 v153, 0xbfb8aa3b, v73
    v_mul_f32 v154, 0xbfb8aa3b, v74
    v_mul_f32 v155, 0xbfb8aa3b, v75
    v_mul_f32 v156, 0xbfb8aa3b, v76
    v_mul_f32 v157, 0xbfb8aa3b, v77
    v_mul_f32 v158, 0xbfb8aa3b, v78
    v_mul_f32 v159, 0xbfb8aa3b, v79
    v_exp_f32 v144, v144
    v_exp_f32 v145, v145
    v_exp_f32 v146, v146
    v_exp_f32 v147, v147
    v_exp_f32 v148, v148
    v_exp_f32 v149, v149
    v_exp_f32 v150, v150
    v_exp_f32 v151, v151
    v_exp_f32 v152, v152
    v_exp_f32 v153, v153
    v_exp_f32 v154, v154
    v_exp_f32 v155, v155
    v_exp_f32 v156, v156
    v_exp_f32 v157, v157
    v_exp_f32 v158, v158
    v_exp_f32 v159, v159
    v_pk_add_f32 v[144:145], v[144:145], v[28:29]
    v_pk_add_f32 v[146:147], v[146:147], v[28:29]
    v_pk_add_f32 v[148:149], v[148:149], v[28:29]
    v_pk_add_f32 v[150:151], v[150:151], v[28:29]
    v_pk_add_f32 v[152:153], v[152:153], v[28:29]
    v_pk_add_f32 v[154:155], v[154:155], v[28:29]
    v_pk_add_f32 v[156:157], v[156:157], v[28:29]
    v_pk_add_f32 v[158:159], v[158:159], v[28:29]
    v_rcp_f32 v144, v144
    v_rcp_f32 v145, v145
    v_rcp_f32 v146, v146
    v_rcp_f32 v147, v147
    v_rcp_f32 v148, v148
    v_rcp_f32 v149, v149
    v_rcp_f32 v150, v150
    v_rcp_f32 v151, v151
    v_rcp_f32 v152, v152
    v_rcp_f32 v153, v153
    v_rcp_f32 v154, v154
    v_rcp_f32 v155, v155
    v_rcp_f32 v156, v156
    v_rcp_f32 v157, v157
    v_rcp_f32 v158, v158
    v_rcp_f32 v159, v159
    v_pk_mul_f32 v[64:65], v[64:65], v[144:145]
    v_pk_mul_f32 v[66:67], v[66:67], v[146:147]
    v_pk_mul_f32 v[68:69], v[68:69], v[148:149]
    v_pk_mul_f32 v[70:71], v[70:71], v[150:151]
    v_pk_mul_f32 v[72:73], v[72:73], v[152:153]
    v_pk_mul_f32 v[74:75], v[74:75], v[154:155]
    v_pk_mul_f32 v[76:77], v[76:77], v[156:157]
    v_pk_mul_f32 v[78:79], v[78:79], v[158:159]
    v_cvt_pk_bf16_f32 v192, v64, v65
    v_cvt_pk_bf16_f32 v193, v66, v67
    v_cvt_pk_bf16_f32 v194, v68, v69
    v_cvt_pk_bf16_f32 v195, v70, v71
    v_cvt_pk_bf16_f32 v196, v72, v73
    v_cvt_pk_bf16_f32 v197, v74, v75
    v_cvt_pk_bf16_f32 v198, v76, v77
    v_cvt_pk_bf16_f32 v199, v78, v79
    s_cmp_eq_u32 s56, 1
    s_cbranch_scc1 L_sm_121
    s_add_u32 s52, s47, 0
    s_cmp_ge_u32 s52, 80
    s_cselect_b32 s53, 80, 0
    s_add_u32 s52, s52, s53
    s_lshl_b32 s52, s52, 15
    buffer_store_dwordx4 v[192:195], v22, s[32:35], s52 offen sc1
    s_add_u32 s52, s47, 2
    s_cmp_ge_u32 s52, 80
    s_cselect_b32 s53, 80, 0
    s_add_u32 s52, s52, s53
    s_lshl_b32 s52, s52, 15
    buffer_store_dwordx4 v[196:199], v22, s[32:35], s52 offen sc1
    s_branch L_sm_122
L_sm_121:
    s_add_u32 s52, s47, 0
    s_cmp_ge_u32 s52, 80
    s_cselect_b32 s53, 80, 0
    s_add_u32 s52, s52, s53
    s_lshl_b32 s52, s52, 15
    buffer_store_dwordx4 v[192:195], v22, s[32:35], s52 offen
    s_add_u32 s52, s47, 2
    s_cmp_ge_u32 s52, 80
    s_cselect_b32 s53, 80, 0
    s_add_u32 s52, s52, s53
    s_lshl_b32 s52, s52, 15
    buffer_store_dwordx4 v[196:199], v22, s[32:35], s52 offen
L_sm_122:
    v_pk_mul_f32 v[80:81], v[80:81], v[24:25] op_sel_hi:[1,0]
    v_pk_mul_f32 v[82:83], v[82:83], v[24:25] op_sel_hi:[1,0]
    v_pk_mul_f32 v[84:85], v[84:85], v[24:25] op_sel_hi:[1,0]
    v_pk_mul_f32 v[86:87], v[86:87], v[24:25] op_sel_hi:[1,0]
    v_pk_mul_f32 v[88:89], v[88:89], v[24:25] op_sel_hi:[1,0]
    v_pk_mul_f32 v[90:91], v[90:91], v[24:25] op_sel_hi:[1,0]
    v_pk_mul_f32 v[92:93], v[92:93], v[24:25] op_sel_hi:[1,0]
    v_pk_mul_f32 v[94:95], v[94:95], v[24:25] op_sel_hi:[1,0]
    v_pk_fma_f32 v[80:81], v[160:161], v[24:25], v[80:81] op_sel:[0,1,0] op_sel_hi:[1,1,1]
    v_pk_fma_f32 v[82:83], v[162:163], v[24:25], v[82:83] op_sel:[0,1,0] op_sel_hi:[1,1,1]
    v_pk_fma_f32 v[84:85], v[164:165], v[24:25], v[84:85] op_sel:[0,1,0] op_sel_hi:[1,1,1]
    v_pk_fma_f32 v[86:87], v[166:167], v[24:25], v[86:87] op_sel:[0,1,0] op_sel_hi:[1,1,1]
    v_pk_fma_f32 v[88:89], v[168:169], v[24:25], v[88:89] op_sel:[0,1,0] op_sel_hi:[1,1,1]
    v_pk_fma_f32 v[90:91], v[170:171], v[24:25], v[90:91] op_sel:[0,1,0] op_sel_hi:[1,1,1]
    v_pk_fma_f32 v[92:93], v[172:173], v[24:25], v[92:93] op_sel:[0,1,0] op_sel_hi:[1,1,1]
    v_pk_fma_f32 v[94:95], v[174:175], v[24:25], v[94:95] op_sel:[0,1,0] op_sel_hi:[1,1,1]
    v_mul_f32 v160, 0xbfb8aa3b, v80
    v_mul_f32 v161, 0xbfb8aa3b, v81
    v_mul_f32 v162, 0xbfb8aa3b, v82
    v_mul_f32 v163, 0xbfb8aa3b, v83
    v_mul_f32 v164, 0xbfb8aa3b, v84
    v_mul_f32 v165, 0xbfb8aa3b, v85
    v_mul_f32 v166, 0xbfb8aa3b, v86
    v_mul_f32 v167, 0xbfb8aa3b, v87
    v_mul_f32 v168, 0xbfb8aa3b, v88
    v_mul_f32 v169, 0xbfb8aa3b, v89
    v_mul_f32 v170, 0xbfb8aa3b, v90
    v_mul_f32 v171, 0xbfb8aa3b, v91
    v_mul_f32 v172, 0xbfb8aa3b, v92
    v_mul_f32 v173, 0xbfb8aa3b, v93
    v_mul_f32 v174, 0xbfb8aa3b, v94
    v_mul_f32 v175, 0xbfb8aa3b, v95
    v_exp_f32 v160, v160
    v_exp_f32 v161, v161
    v_exp_f32 v162, v162
    v_exp_f32 v163, v163
    v_exp_f32 v164, v164
    v_exp_f32 v165, v165
    v_exp_f32 v166, v166
    v_exp_f32 v167, v167
    v_exp_f32 v168, v168
    v_exp_f32 v169, v169
    v_exp_f32 v170, v170
    v_exp_f32 v171, v171
    v_exp_f32 v172, v172
    v_exp_f32 v173, v173
    v_exp_f32 v174, v174
    v_exp_f32 v175, v175
    v_pk_add_f32 v[160:161], v[160:161], v[28:29]
    v_pk_add_f32 v[162:163], v[162:163], v[28:29]
    v_pk_add_f32 v[164:165], v[164:165], v[28:29]
    v_pk_add_f32 v[166:167], v[166:167], v[28:29]
    v_pk_add_f32 v[168:169], v[168:169], v[28:29]
    v_pk_add_f32 v[170:171], v[170:171], v[28:29]
    v_pk_add_f32 v[172:173], v[172:173], v[28:29]
    v_pk_add_f32 v[174:175], v[174:175], v[28:29]
    v_rcp_f32 v160, v160
    v_rcp_f32 v161, v161
    v_rcp_f32 v162, v162
    v_rcp_f32 v163, v163
    v_rcp_f32 v164, v164
    v_rcp_f32 v165, v165
    v_rcp_f32 v166, v166
    v_rcp_f32 v167, v167
    v_rcp_f32 v168, v168
    v_rcp_f32 v169, v169
    v_rcp_f32 v170, v170
    v_rcp_f32 v171, v171
    v_rcp_f32 v172, v172
    v_rcp_f32 v173, v173
    v_rcp_f32 v174, v174
    v_rcp_f32 v175, v175
    v_pk_mul_f32 v[80:81], v[80:81], v[160:161]
    v_pk_mul_f32 v[82:83], v[82:83], v[162:163]
    v_pk_mul_f32 v[84:85], v[84:85], v[164:165]
    v_pk_mul_f32 v[86:87], v[86:87], v[166:167]
    v_pk_mul_f32 v[88:89], v[88:89], v[168:169]
    v_pk_mul_f32 v[90:91], v[90:91], v[170:171]
    v_pk_mul_f32 v[92:93], v[92:93], v[172:173]
    v_pk_mul_f32 v[94:95], v[94:95], v[174:175]
    v_cvt_pk_bf16_f32 v200, v80, v81
    v_cvt_pk_bf16_f32 v201, v82, v83
    v_cvt_pk_bf16_f32 v202, v84, v85
    v_cvt_pk_bf16_f32 v203, v86, v87
    v_cvt_pk_bf16_f32 v204, v88, v89
    v_cvt_pk_bf16_f32 v205, v90, v91
    v_cvt_pk_bf16_f32 v206, v92, v93
    v_cvt_pk_bf16_f32 v207, v94, v95
    s_cmp_eq_u32 s56, 1
    s_cbranch_scc1 L_sm_123
    s_add_u32 s52, s47, 4
    s_cmp_ge_u32 s52, 80
    s_cselect_b32 s53, 80, 0
    s_add_u32 s52, s52, s53
    s_lshl_b32 s52, s52, 15
    buffer_store_dwordx4 v[200:203], v22, s[32:35], s52 offen sc1
    s_add_u32 s52, s47, 6
    s_cmp_ge_u32 s52, 80
    s_cselect_b32 s53, 80, 0
    s_add_u32 s52, s52, s53
    s_lshl_b32 s52, s52, 15
    buffer_store_dwordx4 v[204:207], v22, s[32:35], s52 offen sc1
    s_branch L_sm_124
L_sm_123:
    s_add_u32 s52, s47, 4
    s_cmp_ge_u32 s52, 80
    s_cselect_b32 s53, 80, 0
    s_add_u32 s52, s52, s53
    s_lshl_b32 s52, s52, 15
    buffer_store_dwordx4 v[200:203], v22, s[32:35], s52 offen
    s_add_u32 s52, s47, 6
    s_cmp_ge_u32 s52, 80
    s_cselect_b32 s53, 80, 0
    s_add_u32 s52, s52, s53
    s_lshl_b32 s52, s52, 15
    buffer_store_dwordx4 v[204:207], v22, s[32:35], s52 offen
L_sm_124:
    v_pk_mul_f32 v[96:97], v[96:97], v[24:25] op_sel_hi:[1,0]
    v_pk_mul_f32 v[98:99], v[98:99], v[24:25] op_sel_hi:[1,0]
    v_pk_mul_f32 v[100:101], v[100:101], v[24:25] op_sel_hi:[1,0]
    v_pk_mul_f32 v[102:103], v[102:103], v[24:25] op_sel_hi:[1,0]
    v_pk_mul_f32 v[104:105], v[104:105], v[24:25] op_sel_hi:[1,0]
    v_pk_mul_f32 v[106:107], v[106:107], v[24:25] op_sel_hi:[1,0]
    v_pk_mul_f32 v[108:109], v[108:109], v[24:25] op_sel_hi:[1,0]
    v_pk_mul_f32 v[110:111], v[110:111], v[24:25] op_sel_hi:[1,0]
    v_pk_fma_f32 v[96:97], v[176:177], v[24:25], v[96:97] op_sel:[0,1,0] op_sel_hi:[1,1,1]
    v_pk_fma_f32 v[98:99], v[178:179], v[24:25], v[98:99] op_sel:[0,1,0] op_sel_hi:[1,1,1]
    v_pk_fma_f32 v[100:101], v[180:181], v[24:25], v[100:101] op_sel:[0,1,0] op_sel_hi:[1,1,1]
    v_pk_fma_f32 v[102:103], v[182:183], v[24:25], v[102:103] op_sel:[0,1,0] op_sel_hi:[1,1,1]
    v_pk_fma_f32 v[104:105], v[184:185], v[24:25], v[104:105] op_sel:[0,1,0] op_sel_hi:[1,1,1]
    v_pk_fma_f32 v[106:107], v[186:187], v[24:25], v[106:107] op_sel:[0,1,0] op_sel_hi:[1,1,1]
    v_pk_fma_f32 v[108:109], v[188:189], v[24:25], v[108:109] op_sel:[0,1,0] op_sel_hi:[1,1,1]
    v_pk_fma_f32 v[110:111], v[190:191], v[24:25], v[110:111] op_sel:[0,1,0] op_sel_hi:[1,1,1]
    v_mul_f32 v176, 0xbfb8aa3b, v96
    v_mul_f32 v177, 0xbfb8aa3b, v97
    v_mul_f32 v178, 0xbfb8aa3b, v98
    v_mul_f32 v179, 0xbfb8aa3b, v99
    v_mul_f32 v180, 0xbfb8aa3b, v100
    v_mul_f32 v181, 0xbfb8aa3b, v101
    v_mul_f32 v182, 0xbfb8aa3b, v102
    v_mul_f32 v183, 0xbfb8aa3b, v103
    v_mul_f32 v184, 0xbfb8aa3b, v104
    v_mul_f32 v185, 0xbfb8aa3b, v105
    v_mul_f32 v186, 0xbfb8aa3b, v106
    v_mul_f32 v187, 0xbfb8aa3b, v107
    v_mul_f32 v188, 0xbfb8aa3b, v108
    v_mul_f32 v189, 0xbfb8aa3b, v109
    v_mul_f32 v190, 0xbfb8aa3b, v110
    v_mul_f32 v191, 0xbfb8aa3b, v111
    v_exp_f32 v176, v176
    v_exp_f32 v177, v177
    v_exp_f32 v178, v178
    v_exp_f32 v179, v179
    v_exp_f32 v180, v180
    v_exp_f32 v181, v181
    v_exp_f32 v182, v182
    v_exp_f32 v183, v183
    v_exp_f32 v184, v184
    v_exp_f32 v185, v185
    v_exp_f32 v186, v186
    v_exp_f32 v187, v187
    v_exp_f32 v188, v188
    v_exp_f32 v189, v189
    v_exp_f32 v190, v190
    v_exp_f32 v191, v191
    v_pk_add_f32 v[176:177], v[176:177], v[28:29]
    v_pk_add_f32 v[178:179], v[178:179], v[28:29]
    v_pk_add_f32 v[180:181], v[180:181], v[28:29]
    v_pk_add_f32 v[182:183], v[182:183], v[28:29]
    v_pk_add_f32 v[184:185], v[184:185], v[28:29]
    v_pk_add_f32 v[186:187], v[186:187], v[28:29]
    v_pk_add_f32 v[188:189], v[188:189], v[28:29]
    v_pk_add_f32 v[190:191], v[190:191], v[28:29]
    v_rcp_f32 v176, v176
    v_rcp_f32 v177, v177
    v_rcp_f32 v178, v178
    v_rcp_f32 v179, v179
    v_rcp_f32 v180, v180
    v_rcp_f32 v181, v181
    v_rcp_f32 v182, v182
    v_rcp_f32 v183, v183
    v_rcp_f32 v184, v184
    v_rcp_f32 v185, v185
    v_rcp_f32 v186, v186
    v_rcp_f32 v187, v187
    v_rcp_f32 v188, v188
    v_rcp_f32 v189, v189
    v_rcp_f32 v190, v190
    v_rcp_f32 v191, v191
    v_pk_mul_f32 v[96:97], v[96:97], v[176:177]
    v_pk_mul_f32 v[98:99], v[98:99], v[178:179]
    v_pk_mul_f32 v[100:101], v[100:101], v[180:181]
    v_pk_mul_f32 v[102:103], v[102:103], v[182:183]
    v_pk_mul_f32 v[104:105], v[104:105], v[184:185]
    v_pk_mul_f32 v[106:107], v[106:107], v[186:187]
    v_pk_mul_f32 v[108:109], v[108:109], v[188:189]
    v_pk_mul_f32 v[110:111], v[110:111], v[190:191]
    v_cvt_pk_bf16_f32 v208, v96, v97
    v_cvt_pk_bf16_f32 v209, v98, v99
    v_cvt_pk_bf16_f32 v210, v100, v101
    v_cvt_pk_bf16_f32 v211, v102, v103
    v_cvt_pk_bf16_f32 v212, v104, v105
    v_cvt_pk_bf16_f32 v213, v106, v107
    v_cvt_pk_bf16_f32 v214, v108, v109
    v_cvt_pk_bf16_f32 v215, v110, v111
    s_cmp_eq_u32 s56, 1
    s_cbranch_scc1 L_sm_125
    s_add_u32 s52, s47, 8
    s_cmp_ge_u32 s52, 80
    s_cselect_b32 s53, 80, 0
    s_add_u32 s52, s52, s53
    s_lshl_b32 s52, s52, 15
    buffer_store_dwordx4 v[208:211], v22, s[32:35], s52 offen sc1
    s_add_u32 s52, s47, 10
    s_cmp_ge_u32 s52, 80
    s_cselect_b32 s53, 80, 0
    s_add_u32 s52, s52, s53
    s_lshl_b32 s52, s52, 15
    buffer_store_dwordx4 v[212:215], v22, s[32:35], s52 offen sc1
    s_branch L_sm_126
L_sm_125:
    s_add_u32 s52, s47, 8
    s_cmp_ge_u32 s52, 80
    s_cselect_b32 s53, 80, 0
    s_add_u32 s52, s52, s53
    s_lshl_b32 s52, s52, 15
    buffer_store_dwordx4 v[208:211], v22, s[32:35], s52 offen
    s_add_u32 s52, s47, 10
    s_cmp_ge_u32 s52, 80
    s_cselect_b32 s53, 80, 0
    s_add_u32 s52, s52, s53
    s_lshl_b32 s52, s52, 15
    buffer_store_dwordx4 v[212:215], v22, s[32:35], s52 offen
L_sm_126:
    s_waitcnt vmcnt(0)
    s_barrier
    s_branch L_P5
L_P5:
    s_cmp_ge_u32 s41, 30
    s_cbranch_scc1 L_FIN
    s_mul_i32 s45, s41, 26
    s_lshr_b32 s45, s45, 8
    s_mul_i32 s52, s45, 10
    s_sub_u32 s46, s41, s52
    s_mul_i32 s52, s45, 96
    s_lshl_b32 s43, s40, 8
    s_add_u32 s43, s43, s52
    s_cmp_lt_u32 s42, 4
    s_cbranch_scc1 L_C5
    s_cmp_eq_u32 s42, 6
    s_cbranch_scc1 L_S5
    s_cmp_eq_u32 s42, 7
    s_cbranch_scc1 L_X5
    s_endpgm
L_L5B:
    s_barrier
    s_add_u32 s52, s63, 0
    s_add_u32 m0, s52, 0
    s_nop 0
    buffer_load_dwordx4 v20, s[32:35], s47 offen sc1 lds
    s_add_u32 m0, m0, s62
    s_nop 0
    buffer_load_dwordx4 v21, s[32:35], s47 offen sc1 lds
    s_add_u32 m0, m0, s62
    s_nop 0
    buffer_load_dwordx4 v22, s[32:35], s47 offen sc1 lds
    s_add_u32 m0, m0, s62
    s_nop 0
    buffer_load_dwordx4 v23, s[32:35], s47 offen sc1 lds
    s_add_u32 m0, m0, s62
    s_nop 0
    buffer_load_dwordx4 v24, s[32:35], s47 offen sc1 lds
    s_add_u32 m0, m0, s62
    s_nop 0
    buffer_load_dwordx4 v25, s[32:35], s47 offen sc1 lds
    s_add_u32 m0, m0, s62
    s_nop 0
    buffer_load_dwordx4 v26, s[32:35], s47 offen sc1 lds
    s_add_u32 m0, m0, s62
    s_nop 0
    buffer_load_dwordx4 v27, s[32:35], s47 offen sc1 lds
    s_add_u32 m0, m0, s62
    s_nop 0
    buffer_load_dwordx4 v28, s[32:35], s47 offen sc1 lds
    s_add_u32 m0, m0, s62
    s_nop 0
    buffer_load_dwordx4 v29, s[32:35], s47 offen sc1 lds
    s_add_u32 m0, m0, s62
    s_nop 0
    buffer_load_dwordx4 v30, s[32:35], s47 offen sc1 lds
    s_add_u32 m0, m0, s62
    s_nop 0
    buffer_load_dwordx4 v31, s[32:35], s47 offen sc1 lds
    s_add_u32 s47, s47, 524288
    s_add_u32 s52, s63, 40960
    s_add_u32 m0, s52, 0
    s_nop 0
    buffer_load_dwordx4 v20, s[32:35], s47 offen sc1 lds
    s_add_u32 m0, m0, s62
    s_nop 0
    buffer_load_dwordx4 v21, s[32:35], s47 offen sc1 lds
    s_add_u32 m0, m0, s62
    s_nop 0
    buffer_load_dwordx4 v22, s[32:35], s47 offen sc1 lds
    s_add_u32 m0, m0, s62
    s_nop 0
    buffer_load_dwordx4 v23, s[32:35], s47 offen sc1 lds
    s_add_u32 m0, m0, s62
    s_nop 0
    buffer_load_dwordx4 v24, s[32:35], s47 offen sc1 lds
    s_add_u32 m0, m0, s62
    s_nop 0
    buffer_load_dwordx4 v25, s[32:35], s47 offen sc1 lds
    s_add_u32 m0, m0, s62
    s_nop 0
    buffer_load_dwordx4 v26, s[32:35], s47 offen sc1 lds
    s_add_u32 m0, m0, s62
    s_nop 0
    buffer_load_dwordx4 v27, s[32:35], s47 offen sc1 lds
    s_add_u32 m0, m0, s62
    s_nop 0
    buffer_load_dwordx4 v28, s[32:35], s47 offen sc1 lds
    s_add_u32 m0, m0, s62
    s_nop 0
    buffer_load_dwordx4 v29, s[32:35], s47 offen sc1 lds
    s_add_u32 m0, m0, s62
    s_nop 0
    buffer_load_dwordx4 v30, s[32:35], s47 offen sc1 lds
    s_add_u32 m0, m0, s62
    s_nop 0
    buffer_load_dwordx4 v31, s[32:35], s47 offen sc1 lds
    s_add_u32 s47, s47, 524288
    s_waitcnt vmcnt(12)
    s_barrier
    s_add_u32 s52, s63, 81920
    s_add_u32 m0, s52, 0
    s_nop 0
    buffer_load_dwordx4 v20, s[32:35], s47 offen sc1 lds
    s_add_u32 m0, m0, s62
    s_nop 0
    buffer_load_dwordx4 v21, s[32:35], s47 offen sc1 lds
    s_add_u32 m0, m0, s62
    s_nop 0
    buffer_load_dwordx4 v22, s[32:35], s47 offen sc1 lds
    s_add_u32 m0, m0, s62
    s_nop 0
    buffer_load_dwordx4 v23, s[32:35], s47 offen sc1 lds
    s_add_u32 m0, m0, s62
    s_nop 0
    buffer_load_dwordx4 v24, s[32:35], s47 offen sc1 lds
    s_add_u32 m0, m0, s62
    s_nop 0
    buffer_load_dwordx4 v25, s[32:35], s47 offen sc1 lds
    s_add_u32 m0, m0, s62
    s_nop 0
    buffer_load_dwordx4 v26, s[32:35], s47 offen sc1 lds
    s_add_u32 m0, m0, s62
    s_nop 0
    buffer_load_dwordx4 v27, s[32:35], s47 offen sc1 lds
    s_add_u32 m0, m0, s62
    s_nop 0
    buffer_load_dwordx4 v28, s[32:35], s47 offen sc1 lds
    s_add_u32 m0, m0, s62
    s_nop 0
    buffer_load_dwordx4 v29, s[32:35], s47 offen sc1 lds
    s_add_u32 m0, m0, s62
    s_nop 0
    buffer_load_dwordx4 v30, s[32:35], s47 offen sc1 lds
    s_add_u32 m0, m0, s62
    s_nop 0
    buffer_load_dwordx4 v31, s[32:35], s47 offen sc1 lds
    s_add_u32 s47, s47, 524288
    s_add_u32 s52, s63, 122880
    s_add_u32 m0, s52, 0
    s_nop 0
    buffer_load_dwordx4 v20, s[32:35], s47 offen sc1 lds
    s_add_u32 m0, m0, s62
    s_nop 0
    buffer_load_dwordx4 v21, s[32:35], s47 offen sc1 lds
    s_add_u32 m0, m0, s62
    s_nop 0
    buffer_load_dwordx4 v22, s[32:35], s47 offen sc1 lds
    s_add_u32 m0, m0, s62
    s_nop 0
    buffer_load_dwordx4 v23, s[32:35], s47 offen sc1 lds
    s_add_u32 m0, m0, s62
    s_nop 0
    buffer_load_dwordx4 v24, s[32:35], s47 offen sc1 lds
    s_add_u32 m0, m0, s62
    s_nop 0
    buffer_load_dwordx4 v25, s[32:35], s47 offen sc1 lds
    s_add_u32 m0, m0, s62
    s_nop 0
    buffer_load_dwordx4 v26, s[32:35], s47 offen sc1 lds
    s_add_u32 m0, m0, s62
    s_nop 0
    buffer_load_dwordx4 v27, s[32:35], s47 offen sc1 lds
    s_add_u32 m0, m0, s62
    s_nop 0
    buffer_load_dwordx4 v28, s[32:35], s47 offen sc1 lds
    s_add_u32 m0, m0, s62
    s_nop 0
    buffer_load_dwordx4 v29, s[32:35], s47 offen sc1 lds
    s_add_u32 m0, m0, s62
    s_nop 0
    buffer_load_dwordx4 v30, s[32:35], s47 offen sc1 lds
    s_add_u32 m0, m0, s62
    s_nop 0
    buffer_load_dwordx4 v31, s[32:35], s47 offen sc1 lds
    s_add_u32 s47, s47, 524288
    s_mov_b32 s51, 0
    s_mov_b32 s50, 0
L_L5LOOP:
    s_cmp_eq_u32 s51, 0
    s_cbranch_scc1 L_rw_127
    s_cmp_eq_u32 s51, 1
    s_cbranch_scc1 L_rw_128
    s_cmp_eq_u32 s51, 9
    s_cbranch_scc1 L_rw_129
    s_cmp_gt_u32 s51, 9
    s_cbranch_scc1 L_rw_130
    s_waitcnt vmcnt(40)
    s_branch L_t_132
L_rw_127:
    s_waitcnt vmcnt(24)
    s_branch L_t_132
L_rw_128:
    s_waitcnt vmcnt(32)
    s_branch L_t_132
L_rw_129:
    s_waitcnt vmcnt(20)
    s_branch L_t_132
L_rw_130:
    s_waitcnt vmcnt(0)
L_t_132:
    s_barrier
    s_cmp_gt_u32 s51, 7
    s_cbranch_scc1 L_s_133
    s_add_u32 s52, s63, s50
    s_add_u32 m0, s52, 0
    s_nop 0
    buffer_load_dwordx4 v20, s[32:35], s47 offen sc1 lds
    s_add_u32 m0, m0, s62
    s_nop 0
    buffer_load_dwordx4 v21, s[32:35], s47 offen sc1 lds
    s_add_u32 m0, m0, s62
    s_nop 0
    buffer_load_dwordx4 v22, s[32:35], s47 offen sc1 lds
    s_add_u32 m0, m0, s62
    s_nop 0
    buffer_load_dwordx4 v23, s[32:35], s47 offen sc1 lds
    s_add_u32 m0, m0, s62
    s_nop 0
    buffer_load_dwordx4 v24, s[32:35], s47 offen sc1 lds
    s_add_u32 m0, m0, s62
    s_nop 0
    buffer_load_dwordx4 v25, s[32:35], s47 offen sc1 lds
    s_add_u32 m0, m0, s62
    s_nop 0
    buffer_load_dwordx4 v26, s[32:35], s47 offen sc1 lds
    s_add_u32 m0, m0, s62
    s_nop 0
    buffer_load_dwordx4 v27, s[32:35], s47 offen sc1 lds
    s_add_u32 m0, m0, s62
    s_nop 0
    buffer_load_dwordx4 v28, s[32:35], s47 offen sc1 lds
    s_add_u32 m0, m0, s62
    s_nop 0
    buffer_load_dwordx4 v29, s[32:35], s47 offen sc1 lds
    s_add_u32 m0, m0, s62
    s_nop 0
    buffer_load_dwordx4 v30, s[32:35], s47 offen sc1 lds
    s_add_u32 m0, m0, s62
    s_nop 0
    buffer_load_dwordx4 v31, s[32:35], s47 offen sc1 lds
    s_add_u32 s52, s54, s50
    s_add_u32 m0, s52, 0
    s_nop 0
    buffer_load_dwordx4 v8, s[28:31], s48 offen lds
    s_add_u32 m0, m0, s62
    s_nop 0
    buffer_load_dwordx4 v9, s[28:31], s48 offen lds
    s_add_u32 m0, m0, s62
    s_nop 0
    buffer_load_dwordx4 v10, s[28:31], s48 offen lds
    s_add_u32 m0, m0, s62
    s_nop 0
    buffer_load_dwordx4 v11, s[28:31], s48 offen lds
    s_add_u32 m0, m0, s62
    s_nop 0
    buffer_load_dwordx4 v12, s[28:31], s48 offen lds
    s_add_u32 m0, m0, s62
    s_nop 0
    buffer_load_dwordx4 v13, s[28:31], s48 offen lds
    s_add_u32 m0, m0, s62
    s_nop 0
    buffer_load_dwordx4 v14, s[28:31], s48 offen lds
    s_add_u32 m0, m0, s62
    s_nop 0
    buffer_load_dwordx4 v15, s[28:31], s48 offen lds
    s_add_u32 s47, s47, 524288
    s_add_u32 s48, s48, 163840
    s_cmp_lg_u32 s51, 0
    s_cbranch_scc1 L_jp_134
    s_add_u32 s47, s47, 2621440
L_jp_134:
L_s_133:
    s_add_u32 s50, s50, 40960
    s_cmp_eq_u32 s50, 163840
    s_cselect_b32 s50, 0, s50
    s_add_u32 s51, s51, 1
    s_cmp_lt_u32 s51, 12
    s_cbranch_scc1 L_L5LOOP
    s_barrier
    s_branch L_FIN
L_S5:
    s_mov_b32 s63, 0xffff
    s_cmp_eq_u32 s45, 1
    s_cselect_b32 s63, 0xffff00, s63
    s_cmp_eq_u32 s45, 2
    s_cselect_b32 s63, 0xff000000, s63
    s_lshl_b32 s53, s40, 8
    s_add_u32 s53, s53, 32768
    v_and_b32 v2, 31, v0
    v_lshl_add_u32 v8, v2, 2, s53
    v_mov_b32 v3, s63
    v_lshrrev_b32 v3, v2, v3
    v_and_b32 v3, 1, v3
    v_mul_u32_u24 v9, 5, v3
L_poll_135:
    buffer_load_dword v10, v8, s[32:35], 0 offen sc1
L_poll_136:
    s_waitcnt vmcnt(0)
    v_cmp_lt_u32 s[60:61], v10, v9
    s_nop 2
    s_cmp_eq_u64 s[60:61], 0
    s_cbranch_scc0 L_poll_135
    s_barrier
    s_barrier
    s_mov_b32 s51, 0
L_S5LOOP:
    s_barrier
    s_add_u32 s51, s51, 1
    s_cmp_lt_u32 s51, 12
    s_cbranch_scc1 L_S5LOOP
    s_barrier
    s_branch L_FIN
L_X5:
    s_barrier
    s_barrier
    s_mov_b32 s51, 0
L_X5LOOP:
    s_barrier
    s_add_u32 s51, s51, 1
    s_cmp_lt_u32 s51, 12
    s_cbranch_scc1 L_X5LOOP
    s_barrier
    s_branch L_FIN
L_C5:
    v_and_b32 v1, 31, v0
    v_add_u32 v3, s43, v1
    v_mul_u32_u24 v4, 1280, v3
    s_lshl_b32 s52, s46, 6
    s_and_b32 s53, s42, 1
    s_lshl_b32 s53, s53, 5
    s_add_u32 s52, s52, s53
    s_lshr_b32 s53, s42, 1
    s_lshl_b32 s53, s53, 4
    s_add_u32 s44, s52, s53
    v_lshrrev_b32 v2, 5, v0
    v_lshl_add_u32 v5, v2, 3, s44
    v_lshl_add_u32 v20, v5, 1, v4
    s_mov_b32 s36, s16
    s_mov_b32 s37, s17
    s_mov_b32 s38, 2621440
    s_mov_b32 s39, 0x20000
    v_lshrrev_b32 v2, 5, v0
    v_bfe_u32 v3, v0, 2, 2
    v_bfe_u32 v4, v0, 4, 1
    v_lshlrev_b32 v4, 1, v4
    v_bfe_u32 v5, v0, 1, 1
    v_or_b32 v4, v4, v5
    s_and_b32 s52, s42, 1
    s_lshl_b32 s52, s52, 2
    v_or_b32 v4, s52, v4
    v_bfe_u32 v5, v0, 3, 1
    v_lshlrev_b32 v5, 2, v5
    v_xor_b32 v4, v4, v5
    v_lshlrev_b32 v4, 4, v4
    v_lshl_add_u32 v4, v3, 7, v4
    v_and_b32 v5, 1, v0
    v_lshl_add_u32 v4, v5, 3, v4
    v_mul_u32_u24 v5, 1024, v2
    v_add_u32 v4, v4, v5
    v_add_u32 v16, 0, v4
    s_lshr_b32 s52, s42, 1
    s_lshl_b32 s53, s52, 11
    v_add_u32 v16, s53, v16
    s_mul_i32 s52, s52, 3072
    s_add_u32 s52, s52, 16384
    v_lshl_add_u32 v18, v0, 4, s52
    v_mov_b64 v[64:65], 0
    v_mov_b64 v[66:67], 0
    v_mov_b64 v[68:69], 0
    v_mov_b64 v[70:71], 0
    v_mov_b64 v[72:73], 0
    v_mov_b64 v[74:75], 0
    v_mov_b64 v[76:77], 0
    v_mov_b64 v[78:79], 0
    v_mov_b64 v[80:81], 0
    v_mov_b64 v[82:83], 0
    v_mov_b64 v[84:85], 0
    v_mov_b64 v[86:87], 0
    v_mov_b64 v[88:89], 0
    v_mov_b64 v[90:91], 0
    v_mov_b64 v[92:93], 0
    v_mov_b64 v[94:95], 0
    v_mov_b64 v[96:97], 0
    v_mov_b64 v[98:99], 0
    v_mov_b64 v[100:101], 0
    v_mov_b64 v[102:103], 0
    v_mov_b64 v[104:105], 0
    v_mov_b64 v[106:107], 0
    v_mov_b64 v[108:109], 0
    v_mov_b64 v[110:111], 0
    s_barrier
    s_mov_b32 s49, 0
    s_mov_b32 s48, 0
    s_mov_b32 s51, 0
    v_add_u32 v19, s49, v18
    v_add_u32 v17, s49, v16
    s_barrier
    ds_read_b64_tr_b16 v[112:113], v17 offset:0
    ds_read_b64_tr_b16 v[114:115], v17 offset:512
    ds_read_b128 v[120:123], v19 offset:0
    ds_read_b128 v[124:127], v19 offset:1024
    ds_read_b128 v[128:131], v19 offset:2048
L_B5LOOP:
    s_waitcnt lgkmcnt(0)
    v_mfma_f32_32x32x16_bf16 v[64:79], v[112:115], v[120:123], v[64:79]
    ds_read_b64_tr_b16 v[116:117], v17 offset:4096
    ds_read_b64_tr_b16 v[118:119], v17 offset:4608
    v_mfma_f32_32x32x16_bf16 v[80:95], v[112:115], v[124:127], v[80:95]
    ds_read_b128 v[132:135], v19 offset:6144
    ds_read_b128 v[136:139], v19 offset:7168
    ds_read_b128 v[140:143], v19 offset:8192
    v_mfma_f32_32x32x16_bf16 v[96:111], v[112:115], v[128:131], v[96:111]
    s_waitcnt lgkmcnt(0)
    v_mfma_f32_32x32x16_bf16 v[64:79], v[116:119], v[132:135], v[64:79]
    ds_read_b64_tr_b16 v[112:113], v17 offset:8192
    ds_read_b64_tr_b16 v[114:115], v17 offset:8704
    v_mfma_f32_32x32x16_bf16 v[80:95], v[116:119], v[136:139], v[80:95]
    ds_read_b128 v[120:123], v19 offset:12288
    ds_read_b128 v[124:127], v19 offset:13312
    ds_read_b128 v[128:131], v19 offset:14336
    v_mfma_f32_32x32x16_bf16 v[96:111], v[116:119], v[140:143], v[96:111]
    s_waitcnt lgkmcnt(0)
    v_mfma_f32_32x32x16_bf16 v[64:79], v[112:115], v[120:123], v[64:79]
    ds_read_b64_tr_b16 v[116:117], v17 offset:12288
    ds_read_b64_tr_b16 v[118:119], v17 offset:12800
    v_mfma_f32_32x32x16_bf16 v[80:95], v[112:115], v[124:127], v[80:95]
    ds_read_b128 v[132:135], v19 offset:18432
    ds_read_b128 v[136:139], v19 offset:19456
    ds_read_b128 v[140:143], v19 offset:20480
    s_add_u32 s49, s49, 40960
    s_cmp_eq_u32 s49, 163840
    s_cselect_b32 s49, 0, s49
    s_add_u32 s48, s48, 16384
    v_mfma_f32_32x32x16_bf16 v[96:111], v[112:115], v[128:131], v[96:111]
    v_add_u32 v19, s49, v18
    v_add_u32 v17, s49, v16
    s_waitcnt lgkmcnt(0)
    s_barrier
    v_mfma_f32_32x32x16_bf16 v[64:79], v[116:119], v[132:135], v[64:79]
    ds_read_b64_tr_b16 v[112:113], v17 offset:0
    ds_read_b64_tr_b16 v[114:115], v17 offset:512
    v_mfma_f32_32x32x16_bf16 v[80:95], v[116:119], v[136:139], v[80:95]
    ds_read_b128 v[120:123], v19 offset:0
    ds_read_b128 v[124:127], v19 offset:1024
    ds_read_b128 v[128:131], v19 offset:2048
    v_mfma_f32_32x32x16_bf16 v[96:111], v[116:119], v[140:143], v[96:111]
    s_add_u32 s51, s51, 1
    s_cmp_lt_u32 s51, 12
    s_cbranch_scc1 L_B5LOOP
    s_mul_i32 s52, s42, 6144
    s_add_u32 s52, s52, 0
    v_lshl_add_u32 v2, v0, 4, s52
    s_xor_b32 s52, s42, 2
    s_mul_i32 s52, s52, 6144
    s_add_u32 s52, s52, 0
    v_lshl_add_u32 v3, v0, 4, s52
    s_cmp_ge_u32 s42, 2
    s_cbranch_scc1 L_k1_137
    ds_write_b128 v2, v[72:75] offset:0
    ds_write_b128 v2, v[76:79] offset:1024
    ds_write_b128 v2, v[88:91] offset:2048
    ds_write_b128 v2, v[92:95] offset:3072
    ds_write_b128 v2, v[104:107] offset:4096
    ds_write_b128 v2, v[108:111] offset:5120
    s_waitcnt lgkmcnt(0)
    s_barrier
    ds_read_b128 v[160:163], v3 offset:0
    ds_read_b128 v[164:167], v3 offset:1024
    ds_read_b128 v[168:171], v3 offset:2048
    ds_read_b128 v[172:175], v3 offset:3072
    ds_read_b128 v[176:179], v3 offset:4096
    ds_read_b128 v[180:183], v3 offset:5120
    s_waitcnt lgkmcnt(0)
    v_pk_add_f32 v[160:161], v[160:161], v[64:65]
    v_pk_add_f32 v[162:163], v[162:163], v[66:67]
    v_pk_add_f32 v[164:165], v[164:165], v[68:69]
    v_pk_add_f32 v[166:167], v[166:167], v[70:71]
    v_pk_add_f32 v[168:169], v[168:169], v[80:81]
    v_pk_add_f32 v[170:171], v[170:171], v[82:83]
    v_pk_add_f32 v[172:173], v[172:173], v[84:85]
    v_pk_add_f32 v[174:175], v[174:175], v[86:87]
    v_pk_add_f32 v[176:177], v[176:177], v[96:97]
    v_pk_add_f32 v[178:179], v[178:179], v[98:99]
    v_pk_add_f32 v[180:181], v[180:181], v[100:101]
    v_pk_add_f32 v[182:183], v[182:183], v[102:103]
    s_branch L_kj_138
L_k1_137:
    ds_write_b128 v2, v[64:67] offset:0
    ds_write_b128 v2, v[68:71] offset:1024
    ds_write_b128 v2, v[80:83] offset:2048
    ds_write_b128 v2, v[84:87] offset:3072
    ds_write_b128 v2, v[96:99] offset:4096
    ds_write_b128 v2, v[100:103] offset:5120
    s_waitcnt lgkmcnt(0)
    s_barrier
    ds_read_b128 v[160:163], v3 offset:0
    ds_read_b128 v[164:167], v3 offset:1024
    ds_read_b128 v[168:171], v3 offset:2048
    ds_read_b128 v[172:175], v3 offset:3072
    ds_read_b128 v[176:179], v3 offset:4096
    ds_read_b128 v[180:183], v3 offset:5120
    s_waitcnt lgkmcnt(0)
    v_pk_add_f32 v[160:161], v[160:161], v[72:73]
    v_pk_add_f32 v[162:163], v[162:163], v[74:75]
    v_pk_add_f32 v[164:165], v[164:165], v[76:77]
    v_pk_add_f32 v[166:167], v[166:167], v[78:79]
    v_pk_add_f32 v[168:169], v[168:169], v[88:89]
    v_pk_add_f32 v[170:171], v[170:171], v[90:91]
    v_pk_add_f32 v[172:173], v[172:173], v[92:93]
    v_pk_add_f32 v[174:175], v[174:175], v[94:95]
    v_pk_add_f32 v[176:177], v[176:177], v[104:105]
    v_pk_add_f32 v[178:179], v[178:179], v[106:107]
    v_pk_add_f32 v[180:181], v[180:181], v[108:109]
    v_pk_add_f32 v[182:183], v[182:183], v[110:111]
L_kj_138:
    v_lshlrev_b32 v2, 16, v240
    v_and_b32 v3, 0xffff0000, v240
    v_add_f32 v160, v160, v2
    v_add_f32 v161, v161, v3
    v_cvt_pk_bf16_f32 v24, v160, v161
    v_lshlrev_b32 v2, 16, v241
    v_and_b32 v3, 0xffff0000, v241
    v_add_f32 v162, v162, v2
    v_add_f32 v163, v163, v3
    v_cvt_pk_bf16_f32 v25, v162, v163
    v_lshlrev_b32 v2, 16, v242
    v_and_b32 v3, 0xffff0000, v242
    v_add_f32 v164, v164, v2
    v_add_f32 v165, v165, v3
    v_cvt_pk_bf16_f32 v26, v164, v165
    v_lshlrev_b32 v2, 16, v243
    v_and_b32 v3, 0xffff0000, v243
    v_add_f32 v166, v166, v2
    v_add_f32 v167, v167, v3
    v_cvt_pk_bf16_f32 v27, v166, v167
    v_permlane32_swap_b32 v24, v26
    s_nop 0
    v_permlane32_swap_b32 v25, v27
    s_mov_b32 s52, 0
    buffer_store_dwordx4 v[24:27], v20, s[36:39], s52 offen
    v_lshlrev_b32 v2, 16, v244
    v_and_b32 v3, 0xffff0000, v244
    v_add_f32 v168, v168, v2
    v_add_f32 v169, v169, v3
    v_cvt_pk_bf16_f32 v28, v168, v169
    v_lshlrev_b32 v2, 16, v245
    v_and_b32 v3, 0xffff0000, v245
    v_add_f32 v170, v170, v2
    v_add_f32 v171, v171, v3
    v_cvt_pk_bf16_f32 v29, v170, v171
    v_lshlrev_b32 v2, 16, v246
    v_and_b32 v3, 0xffff0000, v246
    v_add_f32 v172, v172, v2
    v_add_f32 v173, v173, v3
    v_cvt_pk_bf16_f32 v30, v172, v173
    v_lshlrev_b32 v2, 16, v247
    v_and_b32 v3, 0xffff0000, v247
    v_add_f32 v174, v174, v2
    v_add_f32 v175, v175, v3
    v_cvt_pk_bf16_f32 v31, v174, v175
    v_permlane32_swap_b32 v28, v30
    s_nop 0
    v_permlane32_swap_b32 v29, v31
    s_mov_b32 s52, 40960
    buffer_store_dwordx4 v[28:31], v20, s[36:39], s52 offen
    v_lshlrev_b32 v2, 16, v248
    v_and_b32 v3, 0xffff0000, v248
    v_add_f32 v176, v176, v2
    v_add_f32 v177, v177, v3
    v_cvt_pk_bf16_f32 v32, v176, v177
    v_lshlrev_b32 v2, 16, v249
    v_and_b32 v3, 0xffff0000, v249
    v_add_f32 v178, v178, v2
    v_add_f32 v179, v179, v3
    v_cvt_pk_bf16_f32 v33, v178, v179
    v_lshlrev_b32 v2, 16, v250
    v_and_b32 v3, 0xffff0000, v250
    v_add_f32 v180, v180, v2
    v_add_f32 v181, v181, v3
    v_cvt_pk_bf16_f32 v34, v180, v181
    v_lshlrev_b32 v2, 16, v251
    v_and_b32 v3, 0xffff0000, v251
    v_add_f32 v182, v182, v2
    v_add_f32 v183, v183, v3
    v_cvt_pk_bf16_f32 v35, v182, v183
    v_permlane32_swap_b32 v32, v34
    s_nop 0
    v_permlane32_swap_b32 v33, v35
    s_cmp_eq_u32 s45, 2
    s_cbranch_scc1 L_c5s_139
    s_mov_b32 s52, 81920
    buffer_store_dwordx4 v[32:35], v20, s[36:39], s52 offen
L_c5s_139:
    s_branch L_FIN
L_FIN:
L_END:
    s_endpgm
L_CODE_END:
.section .rodata,"a"
.p2align 6
.amdhsa_kernel sequential_preLN__sliding_block__dense_activation_silu__prompt_kernel
  .amdhsa_next_free_vgpr 256
  .amdhsa_next_free_sgpr 102
  .amdhsa_accum_offset 256
  .amdhsa_group_segment_fixed_size 0
  .amdhsa_kernarg_size 72
  .amdhsa_user_sgpr_count 2
  .amdhsa_user_sgpr_kernarg_segment_ptr 1
  .amdhsa_system_sgpr_workgroup_id_x 1
  .amdhsa_float_denorm_mode_32 3
.end_amdhsa_kernel
```
